```python
import torch

def _softmax(x, axis=-1):
    return torch.softmax(x, dim=axis)
def _gelu(x):
    return torch.nn.functional.gelu(x, approximate="tanh")
def _silu(x):
    return torch.nn.functional.silu(x)
def _sigmoid(x):
    return torch.sigmoid(x)
def _layernorm(x, axis=-1, eps=1e-5):
    m = x.mean(dim=axis, keepdim=True)
    v = x.var(dim=axis, keepdim=True, unbiased=False)
    return (x - m) / torch.sqrt(v + eps)
def _scatter_add(tgt, idx, src, axis=0):
    return tgt.clone().index_add_(axis, idx, src)
def _segment_sum(src, seg, n):
    out = torch.zeros((n,) + src.shape[1:], dtype=src.dtype)
    return out.index_add_(0, seg, src)
def _pad(x, pw):
    flat = tuple(v for pair in reversed(pw) for v in pair)
    return torch.nn.functional.pad(x, flat)

kernel_name = 'standalone__dense_activation_relu__prompt'

def setup_inputs():

    _w = (lambda a: (lambda t: t.to(torch.bfloat16) if t.is_floating_point() else t)(torch.as_tensor(a)))
    B, S, D, Dff = 1, 2048, 1024, 3584
    return {
        "x": _w((lambda *s: torch.randn(*s, dtype=torch.bfloat16) * 0.05)(B, S, D)),
        "w1": _w((lambda *s: torch.randn(*s, dtype=torch.bfloat16) * 0.05)(D, Dff)),
        "w2": _w((lambda *s: torch.randn(*s, dtype=torch.bfloat16) * 0.05)(Dff, D)),
    }

def reference(x, w1, w2):
    h = torch.einsum("bsd,df->bsf", x, w1)
    zero = torch.zeros_like(h)
    h = torch.maximum(h, zero)
    return torch.einsum("bsf,fd->bsd", h, w2)
```

```asm
; @launch grid=(256,1,1) block=(512,1,1) lds=163840
.amdgcn_target "amdgcn-amd-amdhsa--gfx950"
.text
.globl standalone__dense_activation_relu__prompt_kernel
.p2align 8
.type standalone__dense_activation_relu__prompt_kernel,@function
standalone__dense_activation_relu__prompt_kernel:
    s_cmp_ge_u32 s2, 256
    s_cbranch_scc1 L_end
    s_load_dwordx4 s[20:23], s[0:1], 0
    s_load_dwordx4 s[28:31], s[0:1], 16
    s_load_dwordx4 s[36:39], s[0:1], 32
    v_lshrrev_b32 v1, 6, v0
    v_and_b32 v0, 63, v0
    v_readfirstlane_b32 s16, v1
    s_and_b32 s17, s2, 7
    s_lshr_b32 s18, s2, 3
    s_and_b32 s19, s16, 3
    s_lshr_b32 s32, s17, 2
    s_and_b32 s53, s17, 3
    s_and_b32 s58, s18, 3
    s_lshr_b32 s55, s18, 2
    s_lshl_b32 s26, s53, 2
    s_add_u32 s26, s26, s58
    s_lshl_b32 s27, s32, 3
    s_add_u32 s27, s27, s55
    s_cmp_ge_u32 s16, 4
    s_cbranch_scc1 L_comp
    s_setprio 1
    s_lshl_b32 s59, s58, 1
    s_add_u32 s59, s59, s55
    s_and_b32 s59, s59, 7
    s_lshl_b32 s33, s32, 1
    s_add_u32 s53, s53, s33
    s_and_b32 s53, s53, 3
    v_lshrrev_b32 v2, 3, v0
    v_and_b32 v3, 7, v0
    v_add_u32 v4, 0, v2
    v_lshrrev_b32 v5, 1, v4
    v_xor_b32 v5, v3, v5
    v_lshlrev_b32 v5, 4, v5
    v_lshl_add_u32 v10, v4, 11, v5
    v_add_u32 v4, 8, v2
    v_lshrrev_b32 v5, 1, v4
    v_xor_b32 v5, v3, v5
    v_lshlrev_b32 v5, 4, v5
    v_lshl_add_u32 v11, v4, 11, v5
    v_add_u32 v12, 30720, v10
    v_add_u32 v13, 29696, v11
    v_subrev_u32 v11, 1024, v11
    s_lshl_b32 s35, s26, 2
    s_add_u32 s35, s35, s19
    s_lshl_b32 s35, s35, 16
    s_mul_i32 s40, s19, 114688
    s_mul_i32 s41, s27, 448
    s_add_u32 s43, s40, s41
    s_mul_i32 s54, s59, 3
    s_lshr_b32 s54, s54, 3
    s_lshl_b32 s51, s54, 7
    s_add_u32 s51, s51, s35
    s_mul_i32 s52, s54, 458752
    s_add_u32 s52, s52, s43
    s_lshl_b32 m0, s19, 12
    s_mov_b32 s6, 4194304
    s_mov_b32 s7, 0x20000
    s_movk_i32 s34, 6720
    v_mul_u32_u24 v4, 2341, v0
    v_lshlrev_b32 v5, 4, v0
    v_and_b32 v6, 32, v0
    v_xor_b32 v6, v6, v5
    v_xor_b32 v7, 32, v5
    v_add_u32 v7, 4096, v7
    v_lshrrev_b32 v8, 16, v4
    v_mad_u32_u24 v16, v8, s34, v5
    v_add_u32 v8, 149824, v4
    v_lshrrev_b32 v8, 16, v8
    v_mad_u32_u24 v17, v8, s34, v5
    v_add_u32 v8, 299648, v4
    v_lshrrev_b32 v8, 16, v8
    v_mad_u32_u24 v18, v8, s34, v5
    v_add_u32 v8, 449472, v4
    v_lshrrev_b32 v8, 16, v8
    v_mad_u32_u24 v19, v8, s34, v6
    v_add_u32 v8, 599296, v4
    v_lshrrev_b32 v8, 16, v8
    v_mad_u32_u24 v20, v8, s34, v7
    v_add_u32 v8, 749120, v4
    v_lshrrev_b32 v8, 16, v8
    v_mad_u32_u24 v21, v8, s34, v7
    v_add_u32 v8, 898944, v4
    v_lshrrev_b32 v8, 16, v8
    v_mad_u32_u24 v22, v8, s34, v7
    s_waitcnt lgkmcnt(0)
    s_mov_b32 s4, s20
    s_and_b32 s5, s21, 0xffff
    buffer_load_dwordx4 v10, s[4:7], s51 offen offset:0 lds
    buffer_load_dwordx4 v11, s[4:7], s51 offen offset:1024 lds
    buffer_load_dwordx4 v12, s[4:7], s51 offen offset:2048 lds
    buffer_load_dwordx4 v13, s[4:7], s51 offen offset:3072 lds
    s_mov_b32 s48, 0
    s_waitcnt lgkmcnt(0)
    s_mov_b32 s24, s38
    s_mov_b32 s25, s39
    s_mov_b32 s56, s36
    s_mov_b32 s57, s37
    s_mov_b32 s4, s20
    s_and_b32 s5, s21, 0xffff
    s_mov_b32 s6, 4194304
    s_mov_b32 s7, 0x20000
    s_mov_b32 s8, s22
    s_and_b32 s9, s23, 0xffff
    s_mov_b32 s10, 7340032
    s_mov_b32 s11, 0x20000
    s_lshl_b32 s38, s19, 12
    s_mul_i32 s39, s19, 7168
    s_add_u32 s39, s39, 16384
    s_mov_b32 s41, 0
    s_mov_b32 m0, s39
    s_mov_b32 s48, 1
    buffer_load_dwordx4 v16, s[8:11], s52 offen offset:0 lds
    buffer_load_dwordx4 v17, s[8:11], s52 offen offset:1024 lds
    buffer_load_dwordx4 v18, s[8:11], s52 offen offset:2048 lds
    buffer_load_dwordx4 v19, s[8:11], s52 offen offset:3072 lds
    s_add_u32 m0, m0, 4096
    s_mov_b32 s41, 90112
    buffer_load_dwordx4 v20, s[8:11], s52 offen offset:0 lds
    buffer_load_dwordx4 v21, s[8:11], s52 offen offset:1024 lds
    buffer_load_dwordx4 v22, s[8:11], s52 offen offset:2048 lds
    v_subrev_u32 v9, 3, v0
    v_max_i32 v9, 0, v9
    s_add_u32 s59, s59, 3
    s_mul_i32 s54, s53, 4
    s_lshr_b32 s54, s54, 2
    s_cmp_eq_u32 s54, 0
    s_cselect_b32 s54, 4, s54
    v_subrev_u32 v4, s54, v9
    v_ashrrev_i32 v4, 2, v4
    v_lshlrev_b32 v5, 2, v4
    v_add_u32 v5, s54, v5
    v_add_u32 v6, 4, v5
    v_min_i32 v6, 13, v6
    v_max_i32 v5, 0, v5
    v_sub_u32 v6, v6, v5
    v_add_u32 v4, 1, v4
    v_mul_u32_u24 v4, 3, v4
    v_add_u32 v4, s59, v4
    v_and_b32 v4, 7, v4
    v_mul_u32_u24 v4, v4, v6
    v_lshrrev_b32 v4, 3, v4
    v_add_u32 v4, v4, v9
    v_sub_u32 v4, v4, v5
    v_sub_u32 v6, v4, v6
    v_min_u32 v4, v4, v6
    v_add_u32 v48, v4, v5
    s_sub_u32 s59, s59, 3
    v_add_u32 v48, 3, v48
    s_mul_i32 s54, s59, 3
    s_lshr_b32 s54, s54, 3
    v_add_u32 v4, s54, v0
    v_subrev_u32 v5, 3, v4
    v_min_u32 v4, v4, v5
    v_cmp_gt_u32 vcc, 3, v0
    s_nop 1
    v_cndmask_b32 v48, v48, v4, vcc
    v_lshlrev_b32 v49, 7, v48
    v_add_u32 v49, s35, v49
    s_mov_b32 s40, 458752
    v_mul_lo_u32 v48, v48, s40
    v_add_u32 v48, s43, v48
    s_mov_b32 s12, s24
    s_and_b32 s13, s25, 0xffff
    s_mov_b32 s14, 25165824
    s_mov_b32 s15, 0x20000
    s_mov_b32 s92, s28
    s_and_b32 s93, s29, 0xffff
    s_mov_b32 s94, 7340032
    s_mov_b32 s95, 0x20000
    s_mov_b32 s44, s56
    s_and_b32 s45, s57, 0xffff
    s_mov_b32 s46, 256
    s_mov_b32 s47, 0x20000
    v_lshlrev_b32 v24, 4, v0
    v_add_u32 v25, 112640, v24
    v_lshrrev_b32 v2, 4, v0
    v_and_b32 v3, 15, v0
    v_add_u32 v4, 0, v2
    v_and_b32 v5, 7, v4
    v_lshlrev_b32 v5, 1, v5
    v_xor_b32 v5, v3, v5
    v_lshlrev_b32 v5, 4, v5
    v_lshl_add_u32 v26, v4, 11, v5
    v_add_u32 v4, 4, v2
    v_and_b32 v5, 7, v4
    v_lshlrev_b32 v5, 1, v5
    v_xor_b32 v5, v3, v5
    v_lshlrev_b32 v5, 4, v5
    v_lshl_add_u32 v27, v4, 11, v5
    v_subrev_u32 v27, 1024, v27
    v_add_u32 v4, 8, v2
    v_and_b32 v5, 7, v4
    v_lshlrev_b32 v5, 1, v5
    v_xor_b32 v5, v3, v5
    v_lshlrev_b32 v5, 4, v5
    v_lshl_add_u32 v28, v4, 11, v5
    v_subrev_u32 v28, 2048, v28
    v_add_u32 v4, 12, v2
    v_and_b32 v5, 7, v4
    v_lshlrev_b32 v5, 1, v5
    v_xor_b32 v5, v3, v5
    v_lshlrev_b32 v5, 4, v5
    v_lshl_add_u32 v29, v4, 11, v5
    v_subrev_u32 v29, 3072, v29
    s_lshl_b32 s35, s26, 3
    s_lshl_b32 s36, s19, 1
    s_add_u32 s35, s35, s36
    s_mul_i32 s35, s35, 114688
    s_mul_i32 s36, s32, 57344
    s_add_u32 s35, s35, s36
    s_lshl_b32 s36, s19, 15
    s_lshl_b32 s37, s55, 8
    s_add_u32 s36, s36, s37
    s_mul_i32 s37, s32, 3670016
    s_add_u32 s36, s36, s37
    s_add_u32 s50, s38, 81920
    s_add_u32 s49, s38, 0
    s_mul_i32 s43, s55, 7
    s_add_u32 s43, s43, 1
    s_lshr_b32 s43, s43, 1
    s_lshr_b32 s33, s55, 1
    s_mul_i32 s33, s33, 5
    s_and_b32 s34, s55, 1
    s_mul_i32 s34, s34, 3
    s_add_u32 s33, s33, s34
    s_mul_i32 s54, s53, 4
    s_lshr_b32 s54, s54, 2
    s_cmp_eq_u32 s54, 0
    s_cselect_b32 s54, 4, s54
    v_subrev_u32 v4, s54, v0
    v_ashrrev_i32 v4, 2, v4
    v_lshlrev_b32 v5, 2, v4
    v_add_u32 v5, s54, v5
    v_add_u32 v6, 4, v5
    v_min_i32 v6, 18, v6
    v_max_i32 v5, 0, v5
    v_sub_u32 v6, v6, v5
    v_add_u32 v4, 1, v4
    v_mul_u32_u24 v4, 3, v4
    v_add_u32 v4, s59, v4
    v_and_b32 v4, 7, v4
    v_mul_u32_u24 v4, v4, v6
    v_lshrrev_b32 v4, 3, v4
    v_add_u32 v4, v4, v0
    v_sub_u32 v4, v4, v5
    v_sub_u32 v6, v4, v6
    v_min_u32 v4, v4, v6
    v_add_u32 v45, v4, v5
    v_add_u32 v4, 2, v45
    v_cmp_le_u32 vcc, s33, v45
    s_nop 1
    v_cndmask_b32 v45, v45, v4, vcc
    v_and_b32 v45, 31, v45
    v_mul_u32_u24 v4, 0x3334, v45
    v_lshrrev_b32 v4, 16, v4
    v_mul_u32_u24 v5, 5, v4
    v_sub_u32 v5, v45, v5
    v_mad_u32_u24 v4, v4, 7, v5
    v_add_u32 v4, 1, v4
    v_add_u32 v6, 1, v4
    v_cmp_le_u32 vcc, 3, v5
    s_nop 1
    v_cndmask_b32 v45, v4, v6, vcc
    v_and_b32 v4, 7, v0
    v_xor_b32 v5, s58, v4
    s_and_b32 s33, s58, 1
    v_xor_b32 v6, s33, v4
    v_min_u32 v6, 6, v6
    v_cmp_gt_u32 vcc, 4, v4
    s_nop 1
    v_cndmask_b32 v4, v6, v5, vcc
    s_add_u32 s33, s55, 1
    v_add_u32 v4, s33, v4
    v_and_b32 v4, 7, v4
    s_nop 0
    v_readlane_b32 s33, v4, 0
    v_readlane_b32 s34, v4, 1
    v_cmp_gt_u32 vcc, 32, v0
    v_mov_b32 v5, s33
    v_mov_b32 v31, s34
    v_cndmask_b32 v31, v31, v5, vcc
    v_lshlrev_b32 v31, 3, v31
    v_mad_u32_u24 v4, v4, 7, 1
    v_lshrrev_b32 v4, 1, v4
    v_cmp_le_u32 vcc, 32, v0
    s_nop 1
    v_cndmask_b32 v45, v45, v4, vcc
    v_min_u32 v45, 27, v45
    v_lshlrev_b32 v46, 17, v45
    v_add_u32 v46, s36, v46
    v_lshlrev_b32 v45, 11, v45
    v_add_u32 v45, s35, v45
    s_lshl_b32 s22, s26, 1
    s_add_u32 s22, s22, s32
    s_lshl_b32 s22, s22, 2
    s_add_u32 s22, s22, s19
    s_lshl_b32 s22, s22, 8
    s_add_u32 s22, s22, 15728640
    s_lshl_b32 s23, s55, 3
    s_add_u32 s23, s23, s22
    v_and_b32 v30, 7, v0
    v_lshlrev_b32 v30, 3, v30
    v_mov_b32 v36, 0
    v_add_u32 v37, s49, v24
    s_lshl_b32 s28, s19, 11
    s_add_u32 s28, s28, 65536
    v_add_u32 v38, 65536, v37
    v_add_u32 v39, 114688, v24
    s_mov_b32 s66, s28
    s_lshl_b32 s20, s43, 11
    s_add_u32 s20, s20, s35
    s_add_u32 s21, s20, 4096
    s_and_b32 s28, s55, 1
    s_mul_i32 s29, s28, -7168
    s_add_u32 s29, s29, 6144
    s_add_u32 s29, s29, s20
    s_lshl_b32 s98, s17, 5
    s_add_u32 s98, s98, s18
    s_lshl_b32 s98, s98, 2
    s_add_u32 s98, s98, s19
    s_mul_i32 s98, s98, 7168
    v_min_u32 v43, 55, v0
    v_lshlrev_b32 v43, 7, v43
    v_and_b32 v4, 15, v0
    v_lshlrev_b32 v4, 7, v4
    v_add_u32 v4, s20, v4
    v_add_u32 v5, 114688, v4
    v_cmp_gt_u32 vcc, 16, v0
    s_lshl_b32 s54, s2, 7
    s_add_u32 s54, s54, 15794176
    v_cndmask_b32 v42, v5, v4, vcc
    v_and_b32 v5, 128, v43
    v_add_u32 v5, s22, v5
    v_cmp_gt_u32 vcc, 32, v0
    s_and_b32 s99, s18, 3
    s_sub_u32 s99, 6, s99
    v_cndmask_b32 v42, v5, v42, vcc
    v_mov_b32 v5, s54
    v_cmp_gt_u32 vcc, 48, v0
    s_and_b32 s62, s19, 1
    s_lshl_b32 s63, s32, 1
    v_cndmask_b32 v42, v5, v42, vcc
    s_sub_u32 s63, s63, s62
    s_xor_b32 s64, s32, 1
    s_lshl_b32 s64, s64, 1
    s_sub_u32 s64, s64, s62
    s_lshl_b32 s67, s63, 11
    s_add_u32 s67, s67, s49
    s_lshl_b32 s68, s64, 11
    s_add_u32 s68, s68, s49
    s_mul_i32 s63, s63, 114688
    s_mul_i32 s64, s64, 114688
    v_add_u32 v50, s63, v45
    v_add_u32 v51, s64, v45
    v_readlane_b32 s51, v49, s48
    v_readlane_b32 s52, v48, s48
    s_add_u32 m0, s41, s38
    s_add_u32 s48, s48, 1
    s_nop 1
    buffer_load_dwordx4 v10, s[4:7], s51 offen offset:0 lds
    buffer_load_dwordx4 v11, s[4:7], s51 offen offset:1024 lds
    buffer_load_dwordx4 v12, s[4:7], s51 offen offset:2048 lds
    buffer_load_dwordx4 v13, s[4:7], s51 offen offset:3072 lds
    s_add_u32 m0, s41, s39
    s_nop 0
    buffer_load_dwordx4 v16, s[8:11], s52 offen offset:0 lds
    buffer_load_dwordx4 v17, s[8:11], s52 offen offset:1024 lds
    buffer_load_dwordx4 v18, s[8:11], s52 offen offset:2048 lds
    buffer_load_dwordx4 v19, s[8:11], s52 offen offset:3072 lds
    s_add_u32 m0, m0, 4096
    s_cmp_eq_u32 s41, 0
    buffer_load_dwordx4 v20, s[8:11], s52 offen offset:0 lds
    buffer_load_dwordx4 v21, s[8:11], s52 offen offset:1024 lds
    buffer_load_dwordx4 v22, s[8:11], s52 offen offset:2048 lds
    s_cselect_b32 s41, 135168, s41
    s_sub_u32 s41, s41, 45056
    s_waitcnt vmcnt(11)
    s_barrier
    v_readlane_b32 s51, v49, s48
    v_readlane_b32 s52, v48, s48
    s_add_u32 m0, s41, s38
    s_add_u32 s48, s48, 1
    s_nop 1
    buffer_load_dwordx4 v10, s[4:7], s51 offen offset:0 lds
    buffer_load_dwordx4 v11, s[4:7], s51 offen offset:1024 lds
    buffer_load_dwordx4 v12, s[4:7], s51 offen offset:2048 lds
    buffer_load_dwordx4 v13, s[4:7], s51 offen offset:3072 lds
    s_add_u32 m0, s41, s39
    s_nop 0
    buffer_load_dwordx4 v16, s[8:11], s52 offen offset:0 lds
    buffer_load_dwordx4 v17, s[8:11], s52 offen offset:1024 lds
    buffer_load_dwordx4 v18, s[8:11], s52 offen offset:2048 lds
    buffer_load_dwordx4 v19, s[8:11], s52 offen offset:3072 lds
    s_add_u32 m0, m0, 4096
    s_cmp_eq_u32 s41, 0
    buffer_load_dwordx4 v20, s[8:11], s52 offen offset:0 lds
    buffer_load_dwordx4 v21, s[8:11], s52 offen offset:1024 lds
    buffer_load_dwordx4 v22, s[8:11], s52 offen offset:2048 lds
    s_cselect_b32 s41, 135168, s41
    s_sub_u32 s41, s41, 45056
    s_mov_b32 s42, 13
L1_loop:
    s_waitcnt vmcnt(11)
L1_bar:
    s_barrier
    v_readlane_b32 s51, v49, s48
    v_readlane_b32 s52, v48, s48
    s_add_u32 m0, s41, s38
    s_add_u32 s48, s48, 1
    s_nop 1
    buffer_load_dwordx4 v10, s[4:7], s51 offen offset:0 lds
    buffer_load_dwordx4 v11, s[4:7], s51 offen offset:1024 lds
    buffer_load_dwordx4 v12, s[4:7], s51 offen offset:2048 lds
    buffer_load_dwordx4 v13, s[4:7], s51 offen offset:3072 lds
    s_add_u32 m0, s41, s39
    s_nop 0
    buffer_load_dwordx4 v16, s[8:11], s52 offen offset:0 lds
    buffer_load_dwordx4 v17, s[8:11], s52 offen offset:1024 lds
    buffer_load_dwordx4 v18, s[8:11], s52 offen offset:2048 lds
    buffer_load_dwordx4 v19, s[8:11], s52 offen offset:3072 lds
    s_add_u32 m0, m0, 4096
    s_cmp_eq_u32 s41, 0
    buffer_load_dwordx4 v20, s[8:11], s52 offen offset:0 lds
    buffer_load_dwordx4 v21, s[8:11], s52 offen offset:1024 lds
    buffer_load_dwordx4 v22, s[8:11], s52 offen offset:2048 lds
    s_cselect_b32 s41, 135168, s41
    s_sub_u32 s41, s41, 45056
    s_cmp_eq_u32 s42, 8
    s_cbranch_scc1 L1_ldf
L1_ldf_ret:
    s_cmp_eq_u32 s42, s99
    s_cbranch_scc1 L1_pt
L1_pt_ret:
    s_sub_u32 s42, s42, 1
    s_cmp_lg_u32 s42, 0
    s_cbranch_scc1 L1_loop
    s_load_dwordx2 s[30:31], s[56:57], 0
    s_cmp_eq_u32 s58, 3
    s_cselect_b32 s33, 0, s58
    s_waitcnt vmcnt(11)
    s_barrier
    s_cmp_eq_u32 s33, 0
    s_cselect_b32 s37, 3, s33
    s_add_u32 s34, s43, s33
    s_lshl_b32 s37, s37, 14
    s_lshl_b32 s34, s34, 17
    s_add_u32 s37, s37, 16384
    s_add_u32 m0, s50, s37
    s_add_u32 s34, s34, s36
    buffer_load_dwordx4 v26, s[92:95], s34 offen offset:0 lds
    buffer_load_dwordx4 v27, s[92:95], s34 offen offset:1024 lds
    buffer_load_dwordx4 v28, s[92:95], s34 offen offset:2048 lds
    buffer_load_dwordx4 v29, s[92:95], s34 offen offset:3072 lds
    s_add_u32 s33, s33, 1
    s_cmp_eq_u32 s33, 3
    s_cselect_b32 s33, 0, s33
    v_readlane_b32 s52, v46, 33
    s_add_u32 m0, s50, 16384
    s_nop 3
    buffer_load_dwordx4 v26, s[92:95], s52 offen offset:0 lds
    buffer_load_dwordx4 v27, s[92:95], s52 offen offset:1024 lds
    buffer_load_dwordx4 v28, s[92:95], s52 offen offset:2048 lds
    buffer_load_dwordx4 v29, s[92:95], s52 offen offset:3072 lds
    s_cmp_eq_u32 s33, 0
    s_cselect_b32 s37, 3, s33
    s_add_u32 s34, s43, s33
    s_lshl_b32 s37, s37, 14
    s_lshl_b32 s34, s34, 17
    s_add_u32 s37, s37, 16384
    s_add_u32 m0, s50, s37
    s_add_u32 s34, s34, s36
    buffer_load_dwordx4 v26, s[92:95], s34 offen offset:0 lds
    buffer_load_dwordx4 v27, s[92:95], s34 offen offset:1024 lds
    buffer_load_dwordx4 v28, s[92:95], s34 offen offset:2048 lds
    buffer_load_dwordx4 v29, s[92:95], s34 offen offset:3072 lds
    s_add_u32 s33, s33, 1
    s_cmp_eq_u32 s33, 3
    s_cselect_b32 s33, 0, s33
    s_waitcnt vmcnt(12)
    s_barrier
    s_cmp_eq_u32 s33, 0
    s_cselect_b32 s37, 3, s33
    s_add_u32 s34, s43, s33
    s_lshl_b32 s37, s37, 14
    s_lshl_b32 s34, s34, 17
    s_add_u32 s37, s37, 16384
    s_add_u32 m0, s50, s37
    s_add_u32 s34, s34, s36
    buffer_load_dwordx4 v26, s[92:95], s34 offen offset:0 lds
    buffer_load_dwordx4 v27, s[92:95], s34 offen offset:1024 lds
    buffer_load_dwordx4 v28, s[92:95], s34 offen offset:2048 lds
    buffer_load_dwordx4 v29, s[92:95], s34 offen offset:3072 lds
    s_add_u32 s33, s33, 1
    s_cmp_eq_u32 s33, 3
    s_cselect_b32 s33, 0, s33
    v_readlane_b32 s52, v46, 32
    s_add_u32 m0, s50, 0
    s_nop 3
    buffer_load_dwordx4 v26, s[92:95], s52 offen offset:0 lds
    buffer_load_dwordx4 v27, s[92:95], s52 offen offset:1024 lds
    buffer_load_dwordx4 v28, s[92:95], s52 offen offset:2048 lds
    buffer_load_dwordx4 v29, s[92:95], s52 offen offset:3072 lds
    s_waitcnt lgkmcnt(0)
    v_mov_b32 v32, s30
    v_mov_b32 v33, s31
    s_cmp_lg_u32 s31, 0
    s_cbranch_scc1 L_nonce_l_ok
L_nonce_l:
    buffer_load_dwordx2 v[32:33], v36, s[44:47], 0 offen sc1
    s_waitcnt vmcnt(0)
    v_readfirstlane_b32 s28, v33
    s_cmp_lg_u32 s28, 0
    s_cbranch_scc1 L_nonce_l_ok
    s_sleep 8
    s_branch L_nonce_l
L_nonce_l_ok:
    s_lshr_b32 s96, s96, s97
    s_and_b32 s96, s96, 15
    s_barrier
    buffer_load_dword v44, v43, s[92:95], s98 offen
    s_barrier
    ds_read_b128 v[64:67], v38 offset:0
    ds_read_b128 v[68:71], v38 offset:2048
    ds_read_b128 v[72:75], v38 offset:1024
    ds_read_b128 v[76:79], v38 offset:3072
    s_waitcnt lgkmcnt(0)
    s_cmp_eq_u32 s96, 8
    s_cbranch_scc0 L_st1_slow
    buffer_store_dwordx4 v[64:67], v24, s[12:15], s20 offen offset:0
    buffer_store_dwordx4 v[68:71], v39, s[12:15], s20 offen offset:0
    buffer_store_dwordx4 v[72:75], v24, s[12:15], s20 offen offset:1024
    buffer_store_dwordx4 v[76:79], v39, s[12:15], s20 offen offset:1024
L_st1_done:
    s_waitcnt vmcnt(9)
    s_barrier
    ds_read_b128 v[80:83], v37 offset:16384
    ds_read_b128 v[84:87], v37 offset:18432
    ds_read_b128 v[88:91], v37 offset:17408
    ds_read_b128 v[92:95], v37 offset:19456
    ds_read_b128 v[96:99], v37 offset:32768
    ds_read_b128 v[100:103], v37 offset:34816
    ds_read_b128 v[104:107], v37 offset:33792
    ds_read_b128 v[108:111], v37 offset:35840
    ds_read_b128 v[112:115], v37 offset:49152
    ds_read_b128 v[116:119], v37 offset:50176
    s_waitcnt vmcnt(0)
    s_cmp_eq_u32 s96, 8
    s_cbranch_scc0 L_fl1_slow
    s_mov_b64 exec, 1
    buffer_store_dwordx2 v[32:33], v36, s[12:15], s23 offen offset:0
    s_mov_b64 exec, -1
L_fl1_done:
L2_spin:
    buffer_load_dwordx2 v[34:35], v31, s[12:15], s22 offen offset:0 sc1
    s_waitcnt vmcnt(0)
    v_cmp_eq_u64 vcc, v[34:35], v[32:33]
    s_nop 1
    s_cmp_eq_u64 vcc, -1
    s_cbranch_scc1 L2_spin_ok
    s_sleep 1
    s_branch L2_spin
L2_spin_ok:
    s_waitcnt lgkmcnt(0)
    v_readlane_b32 s51, v45, 32
    s_add_u32 m0, s49, 49152
    s_nop 3
    buffer_load_dwordx4 v24, s[12:15], s51 offen offset:0 lds
    buffer_load_dwordx4 v24, s[12:15], s51 offen offset:1024 lds
    buffer_load_dwordx4 v25, s[12:15], s51 offen offset:2048 lds
    buffer_load_dwordx4 v25, s[12:15], s51 offen offset:3072 lds
    v_readlane_b32 s51, v45, 33
    s_add_u32 m0, s49, 0
    s_nop 3
    buffer_load_dwordx4 v24, s[12:15], s51 offen offset:0 lds
    buffer_load_dwordx4 v24, s[12:15], s51 offen offset:1024 lds
    buffer_load_dwordx4 v25, s[12:15], s51 offen offset:2048 lds
    buffer_load_dwordx4 v25, s[12:15], s51 offen offset:3072 lds
    buffer_load_dwordx2 v[34:35], v30, s[12:15], s22 offen sc1
    buffer_store_dwordx4 v[80:83], v24, s[12:15], s20 offen offset:2048 sc1
    buffer_store_dwordx4 v[84:87], v39, s[12:15], s20 offen offset:2048 sc1
    buffer_store_dwordx4 v[88:91], v24, s[12:15], s20 offen offset:3072 sc1
    buffer_store_dwordx4 v[92:95], v39, s[12:15], s20 offen offset:3072 sc1
    buffer_store_dwordx4 v[96:99], v24, s[12:15], s21 offen offset:0 sc1
    s_waitcnt vmcnt(6)
    s_barrier
    s_waitcnt vmcnt(5)
    v_cmp_eq_u64 vcc, v[34:35], v[32:33]
    s_nop 1
    s_cmp_eq_u64 vcc, -1
    s_cbranch_scc1 L2_spin1_ok
L2_spin1:
    buffer_load_dwordx2 v[34:35], v30, s[12:15], s22 offen offset:0 sc1
    s_waitcnt vmcnt(0)
    v_cmp_eq_u64 vcc, v[34:35], v[32:33]
    s_nop 1
    s_cmp_eq_u64 vcc, -1
    s_cbranch_scc1 L2_spin1_ok
    s_sleep 1
    s_branch L2_spin1
L2_spin1_ok:
    buffer_store_dwordx4 v[100:103], v39, s[12:15], s21 offen offset:0 sc1
    buffer_store_dwordx4 v[104:107], v24, s[12:15], s21 offen offset:1024 sc1
    buffer_store_dwordx4 v[108:111], v39, s[12:15], s21 offen offset:1024 sc1
    buffer_store_dwordx4 v[112:115], v24, s[12:15], s29 offen offset:0 sc1
    buffer_store_dwordx4 v[116:119], v39, s[12:15], s29 offen offset:0 sc1
    v_readlane_b32 s51, v45, 34
    s_add_u32 m0, s49, 16384
    s_nop 3
    buffer_load_dwordx4 v24, s[12:15], s51 offen offset:0 lds
    buffer_load_dwordx4 v24, s[12:15], s51 offen offset:1024 lds
    buffer_load_dwordx4 v25, s[12:15], s51 offen offset:2048 lds
    buffer_load_dwordx4 v25, s[12:15], s51 offen offset:3072 lds
    v_readlane_b32 s52, v46, 34
    s_add_u32 m0, s50, 32768
    s_nop 3
    buffer_load_dwordx4 v26, s[92:95], s52 offen offset:0 lds
    buffer_load_dwordx4 v27, s[92:95], s52 offen offset:1024 lds
    buffer_load_dwordx4 v28, s[92:95], s52 offen offset:2048 lds
    buffer_load_dwordx4 v29, s[92:95], s52 offen offset:3072 lds
    v_readlane_b32 s51, v45, 35
    s_add_u32 m0, s49, 32768
    s_nop 3
    buffer_load_dwordx4 v24, s[12:15], s51 offen offset:0 lds
    buffer_load_dwordx4 v24, s[12:15], s51 offen offset:1024 lds
    buffer_load_dwordx4 v25, s[12:15], s51 offen offset:2048 lds
    buffer_load_dwordx4 v25, s[12:15], s51 offen offset:3072 lds
    v_readlane_b32 s52, v46, 35
    s_add_u32 m0, s50, 49152
    s_nop 3
    buffer_load_dwordx4 v26, s[92:95], s52 offen offset:0 lds
    buffer_load_dwordx4 v27, s[92:95], s52 offen offset:1024 lds
    buffer_load_dwordx4 v28, s[92:95], s52 offen offset:2048 lds
    buffer_load_dwordx4 v29, s[92:95], s52 offen offset:3072 lds
    s_waitcnt vmcnt(8)
    s_barrier
    v_readlane_b32 s52, v46, 36
    s_add_u32 m0, s50, 0
    s_nop 3
    buffer_load_dwordx4 v26, s[92:95], s52 offen offset:0 lds
    buffer_load_dwordx4 v27, s[92:95], s52 offen offset:1024 lds
    buffer_load_dwordx4 v28, s[92:95], s52 offen offset:2048 lds
    buffer_load_dwordx4 v29, s[92:95], s52 offen offset:3072 lds
    s_cmp_eq_u32 s96, 8
    s_cbranch_scc0 L_fl2_slow
    s_mov_b64 exec, 1
    buffer_store_dwordx2 v[32:33], v36, s[12:15], s23 offen offset:128
    s_mov_b64 exec, -1
L_fl2_done:
    v_readlane_b32 s51, v45, 36
    s_add_u32 m0, s49, 49152
    s_nop 3
    buffer_load_dwordx4 v24, s[12:15], s51 offen offset:0 lds
    buffer_load_dwordx4 v24, s[12:15], s51 offen offset:1024 lds
    buffer_load_dwordx4 v25, s[12:15], s51 offen offset:2048 lds
    buffer_load_dwordx4 v25, s[12:15], s51 offen offset:3072 lds
    v_readlane_b32 s52, v46, 37
    s_add_u32 m0, s50, 16384
    s_nop 3
    buffer_load_dwordx4 v26, s[92:95], s52 offen offset:0 lds
    buffer_load_dwordx4 v27, s[92:95], s52 offen offset:1024 lds
    buffer_load_dwordx4 v28, s[92:95], s52 offen offset:2048 lds
    buffer_load_dwordx4 v29, s[92:95], s52 offen offset:3072 lds
    s_waitcnt vmcnt(13)
    s_barrier
    v_readlane_b32 s51, v45, 37
    s_add_u32 m0, s49, 0
    s_nop 3
    buffer_load_dwordx4 v24, s[12:15], s51 offen offset:0 lds
    buffer_load_dwordx4 v24, s[12:15], s51 offen offset:1024 lds
    buffer_load_dwordx4 v25, s[12:15], s51 offen offset:2048 lds
    buffer_load_dwordx4 v25, s[12:15], s51 offen offset:3072 lds
    v_readlane_b32 s52, v46, 38
    s_add_u32 m0, s50, 32768
    s_nop 3
    buffer_load_dwordx4 v26, s[92:95], s52 offen offset:0 lds
    buffer_load_dwordx4 v27, s[92:95], s52 offen offset:1024 lds
    buffer_load_dwordx4 v28, s[92:95], s52 offen offset:2048 lds
    buffer_load_dwordx4 v29, s[92:95], s52 offen offset:3072 lds
    s_waitcnt vmcnt(12)
    s_barrier
    buffer_load_dwordx2 v[34:35], v30, s[12:15], s22 offen offset:128 sc1
    v_readlane_b32 s51, v45, 38
    s_add_u32 m0, s49, 16384
    s_nop 3
    buffer_load_dwordx4 v24, s[12:15], s51 offen offset:0 lds
    buffer_load_dwordx4 v24, s[12:15], s51 offen offset:1024 lds
    buffer_load_dwordx4 v25, s[12:15], s51 offen offset:2048 lds
    buffer_load_dwordx4 v25, s[12:15], s51 offen offset:3072 lds
    v_readlane_b32 s52, v46, 0
    s_add_u32 m0, s50, 49152
    s_nop 3
    buffer_load_dwordx4 v26, s[92:95], s52 offen offset:0 lds
    buffer_load_dwordx4 v27, s[92:95], s52 offen offset:1024 lds
    buffer_load_dwordx4 v28, s[92:95], s52 offen offset:2048 lds
    buffer_load_dwordx4 v29, s[92:95], s52 offen offset:3072 lds
    s_waitcnt vmcnt(13)
    s_barrier
    s_waitcnt vmcnt(8)
    v_cmp_eq_u64 vcc, v[34:35], v[32:33]
    s_nop 1
    s_cmp_eq_u64 vcc, -1
    s_cbranch_scc1 L2_spin2_ok
L2_spin2:
    buffer_load_dwordx2 v[34:35], v30, s[12:15], s22 offen offset:128 sc1
    s_waitcnt vmcnt(0)
    v_cmp_eq_u64 vcc, v[34:35], v[32:33]
    s_nop 1
    s_cmp_eq_u64 vcc, -1
    s_cbranch_scc1 L2_spin2_ok
    s_sleep 1
    s_branch L2_spin2
L2_spin2_ok:
    v_readlane_b32 s51, v45, 0
    s_add_u32 m0, s49, 32768
    s_nop 3
    buffer_load_dwordx4 v24, s[12:15], s51 offen offset:0 lds
    buffer_load_dwordx4 v24, s[12:15], s51 offen offset:1024 lds
    buffer_load_dwordx4 v25, s[12:15], s51 offen offset:2048 lds
    buffer_load_dwordx4 v25, s[12:15], s51 offen offset:3072 lds
    v_readlane_b32 s52, v46, 1
    s_add_u32 m0, s50, 0
    s_nop 3
    buffer_load_dwordx4 v26, s[92:95], s52 offen offset:0 lds
    buffer_load_dwordx4 v27, s[92:95], s52 offen offset:1024 lds
    buffer_load_dwordx4 v28, s[92:95], s52 offen offset:2048 lds
    buffer_load_dwordx4 v29, s[92:95], s52 offen offset:3072 lds
    s_waitcnt vmcnt(12)
    s_barrier
    v_readlane_b32 s51, v45, 1
    s_add_u32 m0, s49, 49152
    s_nop 3
    buffer_load_dwordx4 v24, s[12:15], s51 offen offset:0 lds
    buffer_load_dwordx4 v24, s[12:15], s51 offen offset:1024 lds
    buffer_load_dwordx4 v25, s[12:15], s51 offen offset:2048 lds
    buffer_load_dwordx4 v25, s[12:15], s51 offen offset:3072 lds
    v_readlane_b32 s51, v45, 2
    s_add_u32 m0, s49, 0
    s_nop 3
    buffer_load_dwordx4 v24, s[12:15], s51 offen offset:0 lds
    buffer_load_dwordx4 v24, s[12:15], s51 offen offset:1024 lds
    buffer_load_dwordx4 v25, s[12:15], s51 offen offset:2048 lds
    buffer_load_dwordx4 v25, s[12:15], s51 offen offset:3072 lds
    v_readlane_b32 s52, v46, 2
    s_add_u32 m0, s50, 16384
    s_nop 3
    buffer_load_dwordx4 v26, s[92:95], s52 offen offset:0 lds
    buffer_load_dwordx4 v27, s[92:95], s52 offen offset:1024 lds
    buffer_load_dwordx4 v28, s[92:95], s52 offen offset:2048 lds
    buffer_load_dwordx4 v29, s[92:95], s52 offen offset:3072 lds
    s_waitcnt vmcnt(16)
    s_barrier
    v_readlane_b32 s51, v45, 3
    s_add_u32 m0, s49, 16384
    s_nop 3
    buffer_load_dwordx4 v24, s[12:15], s51 offen offset:0 lds
    buffer_load_dwordx4 v24, s[12:15], s51 offen offset:1024 lds
    buffer_load_dwordx4 v25, s[12:15], s51 offen offset:2048 lds
    buffer_load_dwordx4 v25, s[12:15], s51 offen offset:3072 lds
    v_readlane_b32 s52, v46, 3
    s_add_u32 m0, s50, 32768
    s_nop 3
    buffer_load_dwordx4 v26, s[92:95], s52 offen offset:0 lds
    buffer_load_dwordx4 v27, s[92:95], s52 offen offset:1024 lds
    buffer_load_dwordx4 v28, s[92:95], s52 offen offset:2048 lds
    buffer_load_dwordx4 v29, s[92:95], s52 offen offset:3072 lds
    s_waitcnt vmcnt(16)
    s_barrier
    v_readlane_b32 s51, v45, 4
    s_add_u32 m0, s49, 32768
    s_nop 3
    buffer_load_dwordx4 v24, s[12:15], s51 offen offset:0 lds
    buffer_load_dwordx4 v24, s[12:15], s51 offen offset:1024 lds
    buffer_load_dwordx4 v25, s[12:15], s51 offen offset:2048 lds
    buffer_load_dwordx4 v25, s[12:15], s51 offen offset:3072 lds
    v_readlane_b32 s52, v46, 4
    s_add_u32 m0, s50, 49152
    s_nop 3
    buffer_load_dwordx4 v26, s[92:95], s52 offen offset:0 lds
    buffer_load_dwordx4 v27, s[92:95], s52 offen offset:1024 lds
    buffer_load_dwordx4 v28, s[92:95], s52 offen offset:2048 lds
    buffer_load_dwordx4 v29, s[92:95], s52 offen offset:3072 lds
    s_waitcnt vmcnt(16)
    s_barrier
    v_readlane_b32 s51, v45, 5
    s_add_u32 m0, s49, 49152
    s_nop 3
    buffer_load_dwordx4 v24, s[12:15], s51 offen offset:0 lds
    buffer_load_dwordx4 v24, s[12:15], s51 offen offset:1024 lds
    buffer_load_dwordx4 v25, s[12:15], s51 offen offset:2048 lds
    buffer_load_dwordx4 v25, s[12:15], s51 offen offset:3072 lds
    v_readlane_b32 s52, v46, 5
    s_add_u32 m0, s50, 0
    s_nop 3
    buffer_load_dwordx4 v26, s[92:95], s52 offen offset:0 lds
    buffer_load_dwordx4 v27, s[92:95], s52 offen offset:1024 lds
    buffer_load_dwordx4 v28, s[92:95], s52 offen offset:2048 lds
    buffer_load_dwordx4 v29, s[92:95], s52 offen offset:3072 lds
    s_waitcnt vmcnt(16)
    s_barrier
    v_readlane_b32 s51, v45, 6
    s_add_u32 m0, s49, 0
    s_nop 3
    buffer_load_dwordx4 v24, s[12:15], s51 offen offset:0 lds
    buffer_load_dwordx4 v24, s[12:15], s51 offen offset:1024 lds
    buffer_load_dwordx4 v25, s[12:15], s51 offen offset:2048 lds
    buffer_load_dwordx4 v25, s[12:15], s51 offen offset:3072 lds
    v_readlane_b32 s52, v46, 6
    s_add_u32 m0, s50, 16384
    s_nop 3
    buffer_load_dwordx4 v26, s[92:95], s52 offen offset:0 lds
    buffer_load_dwordx4 v27, s[92:95], s52 offen offset:1024 lds
    buffer_load_dwordx4 v28, s[92:95], s52 offen offset:2048 lds
    buffer_load_dwordx4 v29, s[92:95], s52 offen offset:3072 lds
    s_waitcnt vmcnt(16)
    s_barrier
    v_readlane_b32 s51, v45, 7
    s_add_u32 m0, s49, 16384
    s_nop 3
    buffer_load_dwordx4 v24, s[12:15], s51 offen offset:0 lds
    buffer_load_dwordx4 v24, s[12:15], s51 offen offset:1024 lds
    buffer_load_dwordx4 v25, s[12:15], s51 offen offset:2048 lds
    buffer_load_dwordx4 v25, s[12:15], s51 offen offset:3072 lds
    v_readlane_b32 s52, v46, 7
    s_add_u32 m0, s50, 32768
    s_nop 3
    buffer_load_dwordx4 v26, s[92:95], s52 offen offset:0 lds
    buffer_load_dwordx4 v27, s[92:95], s52 offen offset:1024 lds
    buffer_load_dwordx4 v28, s[92:95], s52 offen offset:2048 lds
    buffer_load_dwordx4 v29, s[92:95], s52 offen offset:3072 lds
    s_waitcnt vmcnt(16)
    s_barrier
    v_readlane_b32 s51, v45, 8
    s_add_u32 m0, s49, 32768
    s_nop 3
    buffer_load_dwordx4 v24, s[12:15], s51 offen offset:0 lds
    buffer_load_dwordx4 v24, s[12:15], s51 offen offset:1024 lds
    buffer_load_dwordx4 v25, s[12:15], s51 offen offset:2048 lds
    buffer_load_dwordx4 v25, s[12:15], s51 offen offset:3072 lds
    v_readlane_b32 s52, v46, 8
    s_add_u32 m0, s50, 49152
    s_nop 3
    buffer_load_dwordx4 v26, s[92:95], s52 offen offset:0 lds
    buffer_load_dwordx4 v27, s[92:95], s52 offen offset:1024 lds
    buffer_load_dwordx4 v28, s[92:95], s52 offen offset:2048 lds
    buffer_load_dwordx4 v29, s[92:95], s52 offen offset:3072 lds
    s_waitcnt vmcnt(16)
    s_barrier
    v_readlane_b32 s51, v45, 9
    s_add_u32 m0, s49, 49152
    s_nop 3
    buffer_load_dwordx4 v24, s[12:15], s51 offen offset:0 lds
    buffer_load_dwordx4 v24, s[12:15], s51 offen offset:1024 lds
    buffer_load_dwordx4 v25, s[12:15], s51 offen offset:2048 lds
    buffer_load_dwordx4 v25, s[12:15], s51 offen offset:3072 lds
    v_readlane_b32 s52, v46, 9
    s_add_u32 m0, s50, 0
    s_nop 3
    buffer_load_dwordx4 v26, s[92:95], s52 offen offset:0 lds
    buffer_load_dwordx4 v27, s[92:95], s52 offen offset:1024 lds
    buffer_load_dwordx4 v28, s[92:95], s52 offen offset:2048 lds
    buffer_load_dwordx4 v29, s[92:95], s52 offen offset:3072 lds
    s_waitcnt vmcnt(16)
    s_barrier
    v_readlane_b32 s51, v45, 10
    s_add_u32 m0, s49, 0
    s_nop 3
    buffer_load_dwordx4 v24, s[12:15], s51 offen offset:0 lds
    buffer_load_dwordx4 v24, s[12:15], s51 offen offset:1024 lds
    buffer_load_dwordx4 v25, s[12:15], s51 offen offset:2048 lds
    buffer_load_dwordx4 v25, s[12:15], s51 offen offset:3072 lds
    v_readlane_b32 s52, v46, 10
    s_add_u32 m0, s50, 16384
    s_nop 3
    buffer_load_dwordx4 v26, s[92:95], s52 offen offset:0 lds
    buffer_load_dwordx4 v27, s[92:95], s52 offen offset:1024 lds
    buffer_load_dwordx4 v28, s[92:95], s52 offen offset:2048 lds
    buffer_load_dwordx4 v29, s[92:95], s52 offen offset:3072 lds
    s_waitcnt vmcnt(16)
    s_barrier
    v_readlane_b32 s51, v45, 11
    s_add_u32 m0, s49, 16384
    s_nop 3
    buffer_load_dwordx4 v24, s[12:15], s51 offen offset:0 lds
    buffer_load_dwordx4 v24, s[12:15], s51 offen offset:1024 lds
    buffer_load_dwordx4 v25, s[12:15], s51 offen offset:2048 lds
    buffer_load_dwordx4 v25, s[12:15], s51 offen offset:3072 lds
    v_readlane_b32 s52, v46, 11
    s_add_u32 m0, s50, 32768
    s_nop 3
    buffer_load_dwordx4 v26, s[92:95], s52 offen offset:0 lds
    buffer_load_dwordx4 v27, s[92:95], s52 offen offset:1024 lds
    buffer_load_dwordx4 v28, s[92:95], s52 offen offset:2048 lds
    buffer_load_dwordx4 v29, s[92:95], s52 offen offset:3072 lds
    s_waitcnt vmcnt(16)
    s_barrier
    v_readlane_b32 s51, v51, 12
    s_add_u32 m0, s68, 32768
    s_nop 3
    buffer_load_dwordx4 v24, s[12:15], s51 offen offset:0 lds
    buffer_load_dwordx4 v24, s[12:15], s51 offen offset:1024 lds
    v_readlane_b32 s52, v46, 12
    s_add_u32 m0, s50, 49152
    s_nop 3
    buffer_load_dwordx4 v26, s[92:95], s52 offen offset:0 lds
    buffer_load_dwordx4 v27, s[92:95], s52 offen offset:1024 lds
    buffer_load_dwordx4 v28, s[92:95], s52 offen offset:2048 lds
    buffer_load_dwordx4 v29, s[92:95], s52 offen offset:3072 lds
    s_waitcnt vmcnt(14)
    s_barrier
    v_readlane_b32 s51, v51, 13
    s_add_u32 m0, s68, 49152
    s_nop 3
    buffer_load_dwordx4 v24, s[12:15], s51 offen offset:0 lds
    buffer_load_dwordx4 v24, s[12:15], s51 offen offset:1024 lds
    v_readlane_b32 s52, v46, 13
    s_add_u32 m0, s50, 0
    s_nop 3
    buffer_load_dwordx4 v26, s[92:95], s52 offen offset:0 lds
    buffer_load_dwordx4 v27, s[92:95], s52 offen offset:1024 lds
    buffer_load_dwordx4 v28, s[92:95], s52 offen offset:2048 lds
    buffer_load_dwordx4 v29, s[92:95], s52 offen offset:3072 lds
    s_waitcnt vmcnt(12)
    s_barrier
    v_readlane_b32 s51, v51, 14
    s_add_u32 m0, s68, 0
    s_nop 3
    buffer_load_dwordx4 v24, s[12:15], s51 offen offset:0 lds
    buffer_load_dwordx4 v24, s[12:15], s51 offen offset:1024 lds
    v_readlane_b32 s52, v46, 14
    s_add_u32 m0, s50, 16384
    s_nop 3
    buffer_load_dwordx4 v26, s[92:95], s52 offen offset:0 lds
    buffer_load_dwordx4 v27, s[92:95], s52 offen offset:1024 lds
    buffer_load_dwordx4 v28, s[92:95], s52 offen offset:2048 lds
    buffer_load_dwordx4 v29, s[92:95], s52 offen offset:3072 lds
    s_waitcnt vmcnt(12)
    s_barrier
    v_readlane_b32 s51, v51, 15
    s_add_u32 m0, s68, 16384
    s_nop 3
    buffer_load_dwordx4 v24, s[12:15], s51 offen offset:0 lds
    buffer_load_dwordx4 v24, s[12:15], s51 offen offset:1024 lds
    v_readlane_b32 s52, v46, 15
    s_add_u32 m0, s50, 32768
    s_nop 3
    buffer_load_dwordx4 v26, s[92:95], s52 offen offset:0 lds
    buffer_load_dwordx4 v27, s[92:95], s52 offen offset:1024 lds
    buffer_load_dwordx4 v28, s[92:95], s52 offen offset:2048 lds
    buffer_load_dwordx4 v29, s[92:95], s52 offen offset:3072 lds
    s_waitcnt vmcnt(12)
    s_barrier
    v_readlane_b32 s51, v51, 16
    s_add_u32 m0, s68, 32768
    s_nop 3
    buffer_load_dwordx4 v24, s[12:15], s51 offen offset:0 lds
    buffer_load_dwordx4 v24, s[12:15], s51 offen offset:1024 lds
    v_readlane_b32 s52, v46, 16
    s_add_u32 m0, s50, 49152
    s_nop 3
    buffer_load_dwordx4 v26, s[92:95], s52 offen offset:0 lds
    buffer_load_dwordx4 v27, s[92:95], s52 offen offset:1024 lds
    buffer_load_dwordx4 v28, s[92:95], s52 offen offset:2048 lds
    buffer_load_dwordx4 v29, s[92:95], s52 offen offset:3072 lds
    s_waitcnt vmcnt(12)
    s_barrier
    v_readlane_b32 s52, v46, 17
    s_add_u32 m0, s50, 0
    s_nop 3
    buffer_load_dwordx4 v26, s[92:95], s52 offen offset:0 lds
    buffer_load_dwordx4 v27, s[92:95], s52 offen offset:1024 lds
    buffer_load_dwordx4 v28, s[92:95], s52 offen offset:2048 lds
    buffer_load_dwordx4 v29, s[92:95], s52 offen offset:3072 lds
    v_readlane_b32 s51, v51, 17
    s_add_u32 m0, s68, 49152
    s_nop 3
    buffer_load_dwordx4 v24, s[12:15], s51 offen offset:0 lds
    buffer_load_dwordx4 v24, s[12:15], s51 offen offset:1024 lds
    s_waitcnt vmcnt(12)
    s_barrier
    v_readlane_b32 s51, v50, 12
    s_add_u32 m0, s66, 0
    s_nop 3
    buffer_load_dwordx4 v24, s[12:15], s51 offen offset:0 lds
    buffer_load_dwordx4 v24, s[12:15], s51 offen offset:1024 lds
    s_waitcnt vmcnt(8)
    s_barrier
    v_readlane_b32 s51, v50, 13
    s_add_u32 m0, s66, 8192
    s_nop 3
    buffer_load_dwordx4 v24, s[12:15], s51 offen offset:0 lds
    buffer_load_dwordx4 v24, s[12:15], s51 offen offset:1024 lds
    v_readlane_b32 s51, v50, 14
    s_add_u32 m0, s67, 0
    s_nop 3
    buffer_load_dwordx4 v24, s[12:15], s51 offen offset:0 lds
    buffer_load_dwordx4 v24, s[12:15], s51 offen offset:1024 lds
    v_readlane_b32 s51, v50, 15
    s_add_u32 m0, s67, 16384
    s_nop 3
    buffer_load_dwordx4 v24, s[12:15], s51 offen offset:0 lds
    buffer_load_dwordx4 v24, s[12:15], s51 offen offset:1024 lds
    s_waitcnt vmcnt(8)
    s_barrier
    v_readlane_b32 s51, v50, 16
    s_add_u32 m0, s67, 32768
    s_nop 3
    buffer_load_dwordx4 v24, s[12:15], s51 offen offset:0 lds
    buffer_load_dwordx4 v24, s[12:15], s51 offen offset:1024 lds
    v_readlane_b32 s51, v50, 17
    s_add_u32 m0, s67, 49152
    s_nop 3
    buffer_load_dwordx4 v24, s[12:15], s51 offen offset:0 lds
    buffer_load_dwordx4 v24, s[12:15], s51 offen offset:1024 lds
    s_waitcnt vmcnt(4)
    s_barrier
    s_waitcnt vmcnt(0)
    s_barrier
    s_endpgm
L1_ldf:
    s_lshl_b32 s71, s26, 1
    s_add_u32 s71, s71, s32
    s_lshl_b32 s71, s71, 2
    s_load_dword s96, s[56:57], s71 offset:128
    s_getreg_b32 s97, hwreg(HW_REG_XCC_ID)
    s_and_b32 s97, s97, 7
    s_lshl_b32 s97, s97, 2
    s_branch L1_ldf_ret
L1_pt:
    s_waitcnt lgkmcnt(0)
    s_lshr_b32 s54, s96, s97
    s_and_b32 s54, s54, 15
    s_cmp_eq_u32 s54, 8
    s_cbranch_scc0 L1_pt_ret
    buffer_load_dword v44, v42, s[12:15], 0 offen sc1
L1_pt2:
    s_waitcnt vmcnt(12)
    s_barrier
    v_readlane_b32 s51, v49, s48
    v_readlane_b32 s52, v48, s48
    s_add_u32 m0, s41, s38
    s_add_u32 s48, s48, 1
    s_nop 1
    buffer_load_dwordx4 v10, s[4:7], s51 offen offset:0 lds
    buffer_load_dwordx4 v11, s[4:7], s51 offen offset:1024 lds
    buffer_load_dwordx4 v12, s[4:7], s51 offen offset:2048 lds
    buffer_load_dwordx4 v13, s[4:7], s51 offen offset:3072 lds
    s_add_u32 m0, s41, s39
    s_nop 0
    buffer_load_dwordx4 v16, s[8:11], s52 offen offset:0 lds
    buffer_load_dwordx4 v17, s[8:11], s52 offen offset:1024 lds
    buffer_load_dwordx4 v18, s[8:11], s52 offen offset:2048 lds
    buffer_load_dwordx4 v19, s[8:11], s52 offen offset:3072 lds
    s_add_u32 m0, m0, 4096
    s_cmp_eq_u32 s41, 0
    buffer_load_dwordx4 v20, s[8:11], s52 offen offset:0 lds
    buffer_load_dwordx4 v21, s[8:11], s52 offen offset:1024 lds
    buffer_load_dwordx4 v22, s[8:11], s52 offen offset:2048 lds
    s_cselect_b32 s41, 135168, s41
    s_sub_u32 s41, s41, 45056
    s_sub_u32 s42, s42, 2
    s_waitcnt vmcnt(12)
    s_branch L1_bar
L_st1_slow:
    buffer_store_dwordx4 v[64:67], v24, s[12:15], s20 offen offset:0 sc1
    buffer_store_dwordx4 v[68:71], v39, s[12:15], s20 offen offset:0 sc1
    buffer_store_dwordx4 v[72:75], v24, s[12:15], s20 offen offset:1024 sc1
    buffer_store_dwordx4 v[76:79], v39, s[12:15], s20 offen offset:1024 sc1
    s_branch L_st1_done
L_fl1_slow:
    s_mov_b64 exec, 1
    buffer_store_dwordx2 v[32:33], v36, s[12:15], s23 offen offset:0 sc1
    s_mov_b64 exec, -1
    s_branch L_fl1_done
L_fl2_slow:
    s_mov_b64 exec, 1
    buffer_store_dwordx2 v[32:33], v36, s[12:15], s23 offen offset:128 sc1
    s_mov_b64 exec, -1
    s_branch L_fl2_done
L_comp:
    s_setprio 1
    s_getpc_b64 s[100:101]
L_pc:
    s_sub_u32 s100, s100, L_pc - standalone__dense_activation_relu__prompt_kernel
    s_subb_u32 s101, s101, 0
    s_lshl_b32 s33, s18, 2
    s_add_u32 s33, s33, s19
    s_lshl_b32 s33, s33, 6
    s_add_u32 s34, s33, 8192
    s_add_u32 s35, s33, 16384
    s_min_u32 s34, s34, L_code_end - standalone__dense_activation_relu__prompt_kernel
    s_min_u32 s35, s35, L_code_end - standalone__dense_activation_relu__prompt_kernel
    s_waitcnt lgkmcnt(0)
    s_load_dword s59, s[100:101], s33
    s_load_dword s59, s[100:101], s34
    s_load_dword s59, s[100:101], s35
    s_mov_b32 s24, s38
    s_mov_b32 s25, s39
    s_mov_b32 s56, s36
    s_mov_b32 s57, s37
    s_mov_b32 s12, s24
    s_and_b32 s13, s25, 0xffff
    s_mov_b32 s14, 25165824
    s_mov_b32 s15, 0x20000
    s_mov_b32 s96, s30
    s_and_b32 s97, s31, 0xffff
    s_mov_b32 s98, 4194304
    s_mov_b32 s99, 0x20000
    s_mov_b32 s44, s56
    s_and_b32 s45, s57, 0xffff
    s_mov_b32 s46, 256
    s_mov_b32 s47, 0x20000
    v_mov_b32 v246, 0
    s_cmp_eq_u32 s19, 1
    s_cbranch_scc0 L_c_noxcc
    s_getreg_b32 s20, hwreg(HW_REG_XCC_ID)
    s_and_b32 s20, s20, 7
    s_lshl_b32 s20, s20, 2
    s_lshl_b32 s23, 1, s20
    s_lshl_b32 s21, s26, 1
    s_add_u32 s21, s21, s32
    s_lshl_b32 s21, s21, 2
    v_mov_b32 v2, s23
    s_mov_b64 exec, 1
    buffer_atomic_add v2, v246, s[44:47], s21 offen offset:128 sc1
    s_mov_b64 exec, -1
L_c_noxcc:
    s_or_b32 s20, s19, s2
    s_cmp_eq_u32 s20, 0
    s_cbranch_scc0 L_c_nononce
    s_memrealtime s[40:41]
    s_waitcnt lgkmcnt(0)
    s_or_b32 s41, s41, 0x80000000
    v_mov_b32 v2, s40
    v_mov_b32 v3, s41
    s_mov_b64 exec, 1
    buffer_store_dwordx2 v[2:3], v246, s[44:47], 0 offen sc1
    s_mov_b64 exec, -1
L_c_nononce:
    s_and_b32 s33, s19, 1
    s_lshr_b32 s34, s19, 1
    s_and_b32 s38, s55, 1
    v_and_b32 v2, 15, v0
    v_lshrrev_b32 v3, 4, v0
    v_lshrrev_b32 v4, 1, v2
    v_xor_b32 v4, v3, v4
    v_lshlrev_b32 v4, 4, v4
    v_lshl_add_u32 v4, v2, 7, v4
    s_lshl_b32 s35, s33, 13
    v_add_u32 v10, s35, v4
    v_xor_b32 v11, 64, v10
    v_lshrrev_b32 v5, 2, v0
    v_and_b32 v5, 3, v5
    v_lshl_add_u32 v5, v3, 3, v5
    v_mul_u32_u24 v5, 448, v5
    v_and_b32 v6, 3, v0
    v_lshl_add_u32 v5, v6, 3, v5
    v_add_u32 v5, 16384, v5
    v_and_b32 v6, 1, v3
    v_lshlrev_b32 v6, 5, v6
    s_add_u32 s39, s34, s38
    s_lshl_b32 s35, s39, 6
    v_add_u32 v7, s35, v5
    v_add_u32 v12, v7, v6
    v_sub_u32 v13, v7, v6
    s_mul_i32 s35, s38, -384
    s_add_u32 s35, s35, 384
    v_add_u32 v7, s35, v5
    v_add_u32 v14, v7, v6
    v_sub_u32 v7, v7, v6
    v_add_u32 v7, 32, v7
    s_cmp_eq_u32 s34, 1
    s_cselect_b64 vcc, -1, 0
    v_cndmask_b32 v14, v14, v7, vcc
    v_lshlrev_b32 v1, 4, v0
    s_lshl_b32 s35, s33, 13
    s_lshl_b32 s36, s34, 10
    s_add_u32 s35, s35, s36
    v_add_u32 v250, s35, v1
    s_lshl_b32 s35, s33, 12
    s_add_u32 s35, s35, 65536
    v_add_u32 v252, s35, v1
    s_lshl_b32 s35, s33, 13
    s_lshl_b32 s36, s34, 3
    s_add_u32 s35, s35, s36
    s_add_u32 s35, s35, 49152
    v_add_u32 v251, s35, v1
    v_add_u32 v253, 65536, v250
    s_lshl_b32 s35, s33, 13
    s_lshl_b32 s36, s32, 12
    s_add_u32 s35, s35, s36
    v_add_u32 v24, s35, v1
    v_xor_b32 v25, 4096, v24
    v_lshrrev_b32 v5, 2, v0
    v_and_b32 v5, 3, v5
    v_lshl_add_u32 v5, v3, 2, v5
    v_and_b32 v6, 7, v5
    v_lshlrev_b32 v5, 8, v5
    v_and_b32 v7, 3, v0
    v_lshl_add_u32 v5, v7, 3, v5
    v_add_u32 v5, 81920, v5
    s_lshl_b32 s35, s34, 2
    s_add_u32 s36, s35, 0
    v_xor_b32 v7, s36, v6
    v_lshl_add_u32 v26, v7, 5, v5
    s_add_u32 s36, s35, 1
    v_xor_b32 v7, s36, v6
    v_lshl_add_u32 v27, v7, 5, v5
    s_add_u32 s36, s35, 2
    v_xor_b32 v7, s36, v6
    v_lshl_add_u32 v28, v7, 5, v5
    s_add_u32 s36, s35, 3
    v_xor_b32 v7, s36, v6
    v_lshl_add_u32 v29, v7, 5, v5
    s_lshl_b32 s84, s2, 2
    s_add_u32 s84, s84, s19
    s_lshl_b32 s84, s84, 13
    s_add_u32 s84, s84, 16777216
    s_add_u32 s85, s84, 4096
    s_xor_b32 s86, s84, 131072
    s_add_u32 s87, s86, 4096
    s_lshl_b32 s88, s2, 7
    s_lshl_b32 s89, s19, 3
    s_add_u32 s88, s88, s89
    s_add_u32 s88, s88, 15794176
    s_xor_b32 s89, s88, 512
    s_lshl_b32 s48, s26, 1
    s_add_u32 s48, s48, s33
    s_lshl_b32 s48, s48, 1
    s_add_u32 s48, s48, s32
    s_lshl_b32 s48, s48, 16
    s_lshl_b32 s49, s55, 8
    s_add_u32 s48, s48, s49
    s_lshl_b32 s49, s34, 7
    s_add_u32 s48, s48, s49
    s_add_u32 s49, s48, 16384
    s_add_u32 s50, s48, 32768
    s_add_u32 s51, s48, 49152
    s_lshl_b32 s52, s34, 14
    s_lshl_b32 s35, s33, 13
    s_add_u32 s52, s52, s35
    s_xor_b32 s35, s32, 1
    s_lshl_b32 s35, s35, 12
    s_add_u32 s52, s52, s35
    v_mov_b64 v[128:129], 0
    v_mov_b64 v[130:131], 0
    v_mov_b64 v[132:133], 0
    v_mov_b64 v[134:135], 0
    v_mov_b64 v[136:137], 0
    v_mov_b64 v[138:139], 0
    v_mov_b64 v[140:141], 0
    v_mov_b64 v[142:143], 0
    v_mov_b64 v[144:145], 0
    v_mov_b64 v[146:147], 0
    v_mov_b64 v[148:149], 0
    v_mov_b64 v[150:151], 0
    v_mov_b64 v[152:153], 0
    v_mov_b64 v[154:155], 0
    v_mov_b64 v[156:157], 0
    v_mov_b64 v[158:159], 0
    v_mov_b64 v[160:161], 0
    v_mov_b64 v[162:163], 0
    v_mov_b64 v[164:165], 0
    v_mov_b64 v[166:167], 0
    v_mov_b64 v[168:169], 0
    v_mov_b64 v[170:171], 0
    v_mov_b64 v[172:173], 0
    v_mov_b64 v[174:175], 0
    v_mov_b64 v[176:177], 0
    v_mov_b64 v[178:179], 0
    v_mov_b64 v[180:181], 0
    v_mov_b64 v[182:183], 0
    v_mov_b64 v[184:185], 0
    v_mov_b64 v[186:187], 0
    v_mov_b64 v[188:189], 0
    v_mov_b64 v[190:191], 0
    v_mov_b64 v[192:193], 0
    v_mov_b64 v[194:195], 0
    v_mov_b64 v[196:197], 0
    v_mov_b64 v[198:199], 0
    v_mov_b64 v[200:201], 0
    v_mov_b64 v[202:203], 0
    v_mov_b64 v[204:205], 0
    v_mov_b64 v[206:207], 0
    v_mov_b64 v[208:209], 0
    v_mov_b64 v[210:211], 0
    v_mov_b64 v[212:213], 0
    v_mov_b64 v[214:215], 0
    v_mov_b64 v[216:217], 0
    v_mov_b64 v[218:219], 0
    v_mov_b64 v[220:221], 0
    v_mov_b64 v[222:223], 0
    v_mov_b64 v[224:225], 0
    v_mov_b64 v[226:227], 0
    v_mov_b64 v[228:229], 0
    v_mov_b64 v[230:231], 0
    v_mov_b64 v[232:233], 0
    v_mov_b64 v[234:235], 0
    v_mov_b64 v[236:237], 0
    v_mov_b64 v[238:239], 0
    s_mov_b32 s41, 0
    v_add_u32 v16, s41, v10
    v_add_u32 v17, s41, v12
    v_add_u32 v18, s41, v13
    v_add_u32 v19, s41, v14
    v_add_u32 v20, s41, v11
    v_add_u32 v21, s41, v12
    v_add_u32 v22, s41, v13
    v_add_u32 v23, s41, v14
    s_barrier
    ds_read_b128 v[32:35], v16 offset:0
    ds_read_b128 v[36:39], v16 offset:2048
    ds_read_b128 v[40:43], v16 offset:4096
    ds_read_b128 v[44:47], v16 offset:6144
    ds_read_b64_tr_b16 v[48:49], v17 offset:0
    ds_read_b64_tr_b16 v[50:51], v17 offset:1792
    ds_read_b64_tr_b16 v[52:53], v18 offset:32
    ds_read_b64_tr_b16 v[54:55], v18 offset:1824
    ds_read_b64_tr_b16 v[56:57], v17 offset:128
    ds_read_b64_tr_b16 v[58:59], v17 offset:1920
    ds_read_b64_tr_b16 v[60:61], v18 offset:160
    ds_read_b64_tr_b16 v[62:63], v18 offset:1952
    ds_read_b64_tr_b16 v[64:65], v17 offset:256
    ds_read_b64_tr_b16 v[66:67], v17 offset:2048
    ds_read_b64_tr_b16 v[68:69], v18 offset:288
    ds_read_b64_tr_b16 v[70:71], v18 offset:2080
    ds_read_b64_tr_b16 v[72:73], v19 offset:0
    ds_read_b64_tr_b16 v[74:75], v19 offset:1792
    s_mov_b32 s42, 16
C1_loop:
    s_waitcnt lgkmcnt(0)
    v_mfma_f32_16x16x32_bf16 v[128:131], v[48:51], v[32:35], v[128:131]
    ds_read_b128 v[80:83], v20 offset:0
    v_mfma_f32_16x16x32_bf16 v[132:135], v[48:51], v[36:39], v[132:135]
    ds_read_b128 v[84:87], v20 offset:2048
    v_mfma_f32_16x16x32_bf16 v[136:139], v[48:51], v[40:43], v[136:139]
    ds_read_b128 v[88:91], v20 offset:4096
    v_mfma_f32_16x16x32_bf16 v[140:143], v[48:51], v[44:47], v[140:143]
    ds_read_b128 v[92:95], v20 offset:6144
    v_mfma_f32_16x16x32_bf16 v[156:159], v[52:55], v[44:47], v[156:159]
    ds_read_b64_tr_b16 v[96:97], v21 offset:14336
    v_mfma_f32_16x16x32_bf16 v[152:155], v[52:55], v[40:43], v[152:155]
    ds_read_b64_tr_b16 v[98:99], v21 offset:16128
    v_mfma_f32_16x16x32_bf16 v[148:151], v[52:55], v[36:39], v[148:151]
    ds_read_b64_tr_b16 v[100:101], v22 offset:14368
    v_mfma_f32_16x16x32_bf16 v[144:147], v[52:55], v[32:35], v[144:147]
    ds_read_b64_tr_b16 v[102:103], v22 offset:16160
    v_mfma_f32_16x16x32_bf16 v[160:163], v[56:59], v[32:35], v[160:163]
    ds_read_b64_tr_b16 v[104:105], v21 offset:14464
    v_mfma_f32_16x16x32_bf16 v[164:167], v[56:59], v[36:39], v[164:167]
    ds_read_b64_tr_b16 v[106:107], v21 offset:16256
    v_mfma_f32_16x16x32_bf16 v[168:171], v[56:59], v[40:43], v[168:171]
    ds_read_b64_tr_b16 v[108:109], v22 offset:14496
    v_mfma_f32_16x16x32_bf16 v[172:175], v[56:59], v[44:47], v[172:175]
    ds_read_b64_tr_b16 v[110:111], v22 offset:16288
    v_mfma_f32_16x16x32_bf16 v[188:191], v[60:63], v[44:47], v[188:191]
    ds_read_b64_tr_b16 v[112:113], v21 offset:14592
    v_mfma_f32_16x16x32_bf16 v[184:187], v[60:63], v[40:43], v[184:187]
    ds_read_b64_tr_b16 v[114:115], v21 offset:16384
    v_mfma_f32_16x16x32_bf16 v[180:183], v[60:63], v[36:39], v[180:183]
    ds_read_b64_tr_b16 v[116:117], v22 offset:14624
    v_mfma_f32_16x16x32_bf16 v[176:179], v[60:63], v[32:35], v[176:179]
    ds_read_b64_tr_b16 v[118:119], v22 offset:16416
    v_mfma_f32_16x16x32_bf16 v[192:195], v[64:67], v[32:35], v[192:195]
    ds_read_b64_tr_b16 v[120:121], v23 offset:14336
    v_mfma_f32_16x16x32_bf16 v[196:199], v[64:67], v[36:39], v[196:199]
    ds_read_b64_tr_b16 v[122:123], v23 offset:16128
    v_mfma_f32_16x16x32_bf16 v[200:203], v[64:67], v[40:43], v[200:203]
    s_cmp_eq_u32 s41, 0
    v_mfma_f32_16x16x32_bf16 v[204:207], v[64:67], v[44:47], v[204:207]
    s_cselect_b32 s41, 135168, s41
    v_mfma_f32_16x16x32_bf16 v[220:223], v[68:71], v[44:47], v[220:223]
    s_sub_u32 s41, s41, 45056
    v_mfma_f32_16x16x32_bf16 v[216:219], v[68:71], v[40:43], v[216:219]
    v_add_u32 v16, s41, v10
    v_mfma_f32_16x16x32_bf16 v[212:215], v[68:71], v[36:39], v[212:215]
    v_add_u32 v17, s41, v12
    v_mfma_f32_16x16x32_bf16 v[208:211], v[68:71], v[32:35], v[208:211]
    v_add_u32 v18, s41, v13
    v_mfma_f32_16x16x32_bf16 v[224:227], v[72:75], v[32:35], v[224:227]
    v_add_u32 v19, s41, v14
    v_mfma_f32_16x16x32_bf16 v[228:231], v[72:75], v[36:39], v[228:231]
    s_sub_u32 s42, s42, 1
    v_mfma_f32_16x16x32_bf16 v[232:235], v[72:75], v[40:43], v[232:235]
    s_cmp_eq_u32 s42, 0
    v_mfma_f32_16x16x32_bf16 v[236:239], v[72:75], v[44:47], v[236:239]
    s_waitcnt lgkmcnt(0)
    s_barrier
    s_cbranch_scc1 C1_last
    v_mfma_f32_16x16x32_bf16 v[128:131], v[96:99], v[80:83], v[128:131]
    ds_read_b128 v[32:35], v16 offset:0
    v_mfma_f32_16x16x32_bf16 v[132:135], v[96:99], v[84:87], v[132:135]
    ds_read_b128 v[36:39], v16 offset:2048
    v_mfma_f32_16x16x32_bf16 v[136:139], v[96:99], v[88:91], v[136:139]
    ds_read_b128 v[40:43], v16 offset:4096
    v_mfma_f32_16x16x32_bf16 v[140:143], v[96:99], v[92:95], v[140:143]
    ds_read_b128 v[44:47], v16 offset:6144
    v_mfma_f32_16x16x32_bf16 v[156:159], v[100:103], v[92:95], v[156:159]
    ds_read_b64_tr_b16 v[48:49], v17 offset:0
    v_mfma_f32_16x16x32_bf16 v[152:155], v[100:103], v[88:91], v[152:155]
    ds_read_b64_tr_b16 v[50:51], v17 offset:1792
    v_mfma_f32_16x16x32_bf16 v[148:151], v[100:103], v[84:87], v[148:151]
    ds_read_b64_tr_b16 v[52:53], v18 offset:32
    v_mfma_f32_16x16x32_bf16 v[144:147], v[100:103], v[80:83], v[144:147]
    ds_read_b64_tr_b16 v[54:55], v18 offset:1824
    v_mfma_f32_16x16x32_bf16 v[160:163], v[104:107], v[80:83], v[160:163]
    ds_read_b64_tr_b16 v[56:57], v17 offset:128
    v_mfma_f32_16x16x32_bf16 v[164:167], v[104:107], v[84:87], v[164:167]
    ds_read_b64_tr_b16 v[58:59], v17 offset:1920
    v_mfma_f32_16x16x32_bf16 v[168:171], v[104:107], v[88:91], v[168:171]
    ds_read_b64_tr_b16 v[60:61], v18 offset:160
    v_mfma_f32_16x16x32_bf16 v[172:175], v[104:107], v[92:95], v[172:175]
    ds_read_b64_tr_b16 v[62:63], v18 offset:1952
    v_mfma_f32_16x16x32_bf16 v[188:191], v[108:111], v[92:95], v[188:191]
    ds_read_b64_tr_b16 v[64:65], v17 offset:256
    v_mfma_f32_16x16x32_bf16 v[184:187], v[108:111], v[88:91], v[184:187]
    ds_read_b64_tr_b16 v[66:67], v17 offset:2048
    v_mfma_f32_16x16x32_bf16 v[180:183], v[108:111], v[84:87], v[180:183]
    ds_read_b64_tr_b16 v[68:69], v18 offset:288
    v_mfma_f32_16x16x32_bf16 v[176:179], v[108:111], v[80:83], v[176:179]
    ds_read_b64_tr_b16 v[70:71], v18 offset:2080
    v_mfma_f32_16x16x32_bf16 v[192:195], v[112:115], v[80:83], v[192:195]
    ds_read_b64_tr_b16 v[72:73], v19 offset:0
    v_mfma_f32_16x16x32_bf16 v[196:199], v[112:115], v[84:87], v[196:199]
    ds_read_b64_tr_b16 v[74:75], v19 offset:1792
    v_mfma_f32_16x16x32_bf16 v[200:203], v[112:115], v[88:91], v[200:203]
    v_add_u32 v20, s41, v11
    v_mfma_f32_16x16x32_bf16 v[204:207], v[112:115], v[92:95], v[204:207]
    v_add_u32 v21, s41, v12
    v_mfma_f32_16x16x32_bf16 v[220:223], v[116:119], v[92:95], v[220:223]
    v_add_u32 v22, s41, v13
    v_mfma_f32_16x16x32_bf16 v[216:219], v[116:119], v[88:91], v[216:219]
    v_add_u32 v23, s41, v14
    v_mfma_f32_16x16x32_bf16 v[212:215], v[116:119], v[84:87], v[212:215]
    v_mfma_f32_16x16x32_bf16 v[208:211], v[116:119], v[80:83], v[208:211]
    v_mfma_f32_16x16x32_bf16 v[224:227], v[120:123], v[80:83], v[224:227]
    v_mfma_f32_16x16x32_bf16 v[228:231], v[120:123], v[84:87], v[228:231]
    v_mfma_f32_16x16x32_bf16 v[232:235], v[120:123], v[88:91], v[232:235]
    v_mfma_f32_16x16x32_bf16 v[236:239], v[120:123], v[92:95], v[236:239]
    s_branch C1_loop
C1_last:
    v_mfma_f32_16x16x32_bf16 v[128:131], v[96:99], v[80:83], v[128:131]
    v_add_u32 v16, 65536, v24
    v_mfma_f32_16x16x32_bf16 v[132:135], v[96:99], v[84:87], v[132:135]
    v_add_u32 v17, 65536, v25
    v_mfma_f32_16x16x32_bf16 v[136:139], v[96:99], v[88:91], v[136:139]
    v_add_u32 v18, 65536, v26
    v_mfma_f32_16x16x32_bf16 v[140:143], v[96:99], v[92:95], v[140:143]
    v_add_u32 v19, 65536, v27
    v_mfma_f32_16x16x32_bf16 v[156:159], v[100:103], v[92:95], v[156:159]
    v_add_u32 v20, 65536, v28
    v_mfma_f32_16x16x32_bf16 v[152:155], v[100:103], v[88:91], v[152:155]
    v_add_u32 v21, 65536, v29
    v_mfma_f32_16x16x32_bf16 v[148:151], v[100:103], v[84:87], v[148:151]
    s_nop 0
    v_mfma_f32_16x16x32_bf16 v[144:147], v[100:103], v[80:83], v[144:147]
    s_nop 0
    v_mfma_f32_16x16x32_bf16 v[160:163], v[104:107], v[80:83], v[160:163]
    s_nop 0
    v_mfma_f32_16x16x32_bf16 v[164:167], v[104:107], v[84:87], v[164:167]
    s_nop 0
    v_mfma_f32_16x16x32_bf16 v[168:171], v[104:107], v[88:91], v[168:171]
    s_nop 0
    v_mfma_f32_16x16x32_bf16 v[172:175], v[104:107], v[92:95], v[172:175]
    s_nop 0
    v_mfma_f32_16x16x32_bf16 v[188:191], v[108:111], v[92:95], v[188:191]
    v_cvt_pk_bf16_f32 v32, v128, v129
    v_cvt_pk_bf16_f32 v33, v130, v131
    v_cvt_pk_bf16_f32 v34, v144, v145
    v_mfma_f32_16x16x32_bf16 v[184:187], v[108:111], v[88:91], v[184:187]
    v_cvt_pk_bf16_f32 v35, v146, v147
    v_pk_max_i16 v32, v32, 0
    v_pk_max_i16 v33, v33, 0
    v_mfma_f32_16x16x32_bf16 v[180:183], v[108:111], v[84:87], v[180:183]
    v_pk_max_i16 v34, v34, 0
    v_pk_max_i16 v35, v35, 0
    ds_write_b128 v253, v[32:35] offset:0
    v_mfma_f32_16x16x32_bf16 v[176:179], v[108:111], v[80:83], v[176:179]
    v_cvt_pk_bf16_f32 v36, v132, v133
    v_cvt_pk_bf16_f32 v37, v134, v135
    v_cvt_pk_bf16_f32 v38, v148, v149
    v_mfma_f32_16x16x32_bf16 v[192:195], v[112:115], v[80:83], v[192:195]
    v_cvt_pk_bf16_f32 v39, v150, v151
    v_pk_max_i16 v36, v36, 0
    v_pk_max_i16 v37, v37, 0
    v_mfma_f32_16x16x32_bf16 v[196:199], v[112:115], v[84:87], v[196:199]
    v_pk_max_i16 v38, v38, 0
    v_pk_max_i16 v39, v39, 0
    ds_write_b128 v253, v[36:39] offset:2048
    v_mfma_f32_16x16x32_bf16 v[200:203], v[112:115], v[88:91], v[200:203]
    v_cvt_pk_bf16_f32 v40, v136, v137
    v_cvt_pk_bf16_f32 v41, v138, v139
    v_cvt_pk_bf16_f32 v42, v152, v153
    v_mfma_f32_16x16x32_bf16 v[204:207], v[112:115], v[92:95], v[204:207]
    v_cvt_pk_bf16_f32 v43, v154, v155
    v_pk_max_i16 v40, v40, 0
    v_pk_max_i16 v41, v41, 0
    v_mfma_f32_16x16x32_bf16 v[220:223], v[116:119], v[92:95], v[220:223]
    v_pk_max_i16 v42, v42, 0
    v_pk_max_i16 v43, v43, 0
    ds_write_b128 v253, v[40:43] offset:4096
    v_mfma_f32_16x16x32_bf16 v[216:219], v[116:119], v[88:91], v[216:219]
    v_cvt_pk_bf16_f32 v44, v140, v141
    v_cvt_pk_bf16_f32 v45, v142, v143
    v_cvt_pk_bf16_f32 v46, v156, v157
    v_mfma_f32_16x16x32_bf16 v[212:215], v[116:119], v[84:87], v[212:215]
    v_cvt_pk_bf16_f32 v47, v158, v159
    v_pk_max_i16 v44, v44, 0
    v_pk_max_i16 v45, v45, 0
    v_mfma_f32_16x16x32_bf16 v[208:211], v[116:119], v[80:83], v[208:211]
    v_pk_max_i16 v46, v46, 0
    v_pk_max_i16 v47, v47, 0
    ds_write_b128 v253, v[44:47] offset:6144
    v_mfma_f32_16x16x32_bf16 v[224:227], v[120:123], v[80:83], v[224:227]
    v_mfma_f32_16x16x32_bf16 v[228:231], v[120:123], v[84:87], v[228:231]
    v_mfma_f32_16x16x32_bf16 v[232:235], v[120:123], v[88:91], v[232:235]
    v_mfma_f32_16x16x32_bf16 v[236:239], v[120:123], v[92:95], v[236:239]
    v_cvt_pk_bf16_f32 v48, v160, v161
    v_cvt_pk_bf16_f32 v49, v162, v163
    v_cvt_pk_bf16_f32 v50, v176, v177
    v_cvt_pk_bf16_f32 v51, v178, v179
    v_pk_max_i16 v48, v48, 0
    v_pk_max_i16 v49, v49, 0
    v_pk_max_i16 v50, v50, 0
    v_pk_max_i16 v51, v51, 0
    s_waitcnt lgkmcnt(0)
    s_barrier
    ds_write_b128 v250, v[48:51] offset:16384
    v_cvt_pk_bf16_f32 v52, v164, v165
    v_cvt_pk_bf16_f32 v53, v166, v167
    v_cvt_pk_bf16_f32 v54, v180, v181
    v_cvt_pk_bf16_f32 v55, v182, v183
    v_pk_max_i16 v52, v52, 0
    v_pk_max_i16 v53, v53, 0
    v_pk_max_i16 v54, v54, 0
    v_pk_max_i16 v55, v55, 0
    ds_write_b128 v250, v[52:55] offset:18432
    v_cvt_pk_bf16_f32 v56, v168, v169
    v_cvt_pk_bf16_f32 v57, v170, v171
    v_cvt_pk_bf16_f32 v58, v184, v185
    v_cvt_pk_bf16_f32 v59, v186, v187
    v_pk_max_i16 v56, v56, 0
    v_pk_max_i16 v57, v57, 0
    v_pk_max_i16 v58, v58, 0
    v_pk_max_i16 v59, v59, 0
    ds_write_b128 v250, v[56:59] offset:20480
    v_cvt_pk_bf16_f32 v60, v172, v173
    v_cvt_pk_bf16_f32 v61, v174, v175
    v_cvt_pk_bf16_f32 v62, v188, v189
    v_cvt_pk_bf16_f32 v63, v190, v191
    v_pk_max_i16 v60, v60, 0
    v_pk_max_i16 v61, v61, 0
    v_pk_max_i16 v62, v62, 0
    v_pk_max_i16 v63, v63, 0
    ds_write_b128 v250, v[60:63] offset:22528
    v_cvt_pk_bf16_f32 v112, v192, v193
    v_cvt_pk_bf16_f32 v113, v194, v195
    v_cvt_pk_bf16_f32 v114, v208, v209
    v_cvt_pk_bf16_f32 v115, v210, v211
    v_pk_max_i16 v112, v112, 0
    v_pk_max_i16 v113, v113, 0
    v_pk_max_i16 v114, v114, 0
    v_pk_max_i16 v115, v115, 0
    ds_write_b128 v250, v[112:115] offset:32768
    v_cvt_pk_bf16_f32 v116, v196, v197
    v_cvt_pk_bf16_f32 v117, v198, v199
    v_cvt_pk_bf16_f32 v118, v212, v213
    v_cvt_pk_bf16_f32 v119, v214, v215
    v_pk_max_i16 v116, v116, 0
    v_pk_max_i16 v117, v117, 0
    v_pk_max_i16 v118, v118, 0
    v_pk_max_i16 v119, v119, 0
    ds_write_b128 v250, v[116:119] offset:34816
    v_cvt_pk_bf16_f32 v120, v200, v201
    v_cvt_pk_bf16_f32 v121, v202, v203
    v_cvt_pk_bf16_f32 v122, v216, v217
    v_cvt_pk_bf16_f32 v123, v218, v219
    v_pk_max_i16 v120, v120, 0
    v_pk_max_i16 v121, v121, 0
    v_pk_max_i16 v122, v122, 0
    v_pk_max_i16 v123, v123, 0
    ds_write_b128 v250, v[120:123] offset:36864
    v_cvt_pk_bf16_f32 v124, v204, v205
    v_cvt_pk_bf16_f32 v125, v206, v207
    v_cvt_pk_bf16_f32 v126, v220, v221
    v_cvt_pk_bf16_f32 v127, v222, v223
    v_pk_max_i16 v124, v124, 0
    v_pk_max_i16 v125, v125, 0
    v_pk_max_i16 v126, v126, 0
    v_pk_max_i16 v127, v127, 0
    ds_write_b128 v250, v[124:127] offset:38912
    v_cvt_pk_bf16_f32 v64, v224, v225
    v_cvt_pk_bf16_f32 v65, v226, v227
    v_pk_max_i16 v64, v64, 0
    v_pk_max_i16 v65, v65, 0
    ds_write_b64 v251, v[64:65] offset:0
    v_cvt_pk_bf16_f32 v66, v228, v229
    v_cvt_pk_bf16_f32 v67, v230, v231
    v_pk_max_i16 v66, v66, 0
    v_pk_max_i16 v67, v67, 0
    ds_write_b64 v251, v[66:67] offset:1024
    v_cvt_pk_bf16_f32 v68, v232, v233
    v_cvt_pk_bf16_f32 v69, v234, v235
    v_pk_max_i16 v68, v68, 0
    v_pk_max_i16 v69, v69, 0
    ds_write_b64 v251, v[68:69] offset:4096
    v_cvt_pk_bf16_f32 v70, v236, v237
    v_cvt_pk_bf16_f32 v71, v238, v239
    v_pk_max_i16 v70, v70, 0
    v_pk_max_i16 v71, v71, 0
    ds_write_b64 v251, v[70:71] offset:5120
    s_mov_b32 s42, 0
    s_waitcnt lgkmcnt(0)
    s_barrier
    ds_read_b64_tr_b16 v[96:97], v18 offset:0
    ds_read_b64_tr_b16 v[98:99], v18 offset:4096
    ds_read_b128 v[80:83], v16 offset:0
    ds_read_b128 v[84:87], v16 offset:2048
    ds_read_b128 v[88:91], v17 offset:0
    ds_read_b128 v[92:95], v17 offset:2048
    ds_read_b64_tr_b16 v[100:101], v19 offset:0
    ds_read_b64_tr_b16 v[102:103], v19 offset:4096
    ds_read_b64_tr_b16 v[104:105], v20 offset:0
    ds_read_b64_tr_b16 v[106:107], v20 offset:4096
    ds_read_b64_tr_b16 v[108:109], v21 offset:0
    ds_read_b64_tr_b16 v[110:111], v21 offset:4096
    s_waitcnt lgkmcnt(0)
    v_mfma_f32_16x16x32_bf16 v[128:131], v[96:99], v[80:83], 0
    ds_read_b64_tr_b16 v[208:209], v18 offset:8192
    v_mfma_f32_16x16x32_bf16 v[132:135], v[96:99], v[84:87], 0
    ds_read_b64_tr_b16 v[210:211], v18 offset:12288
    v_mfma_f32_16x16x32_bf16 v[136:139], v[96:99], v[88:91], 0
    ds_read_b128 v[192:195], v16 offset:1024
    v_mfma_f32_16x16x32_bf16 v[140:143], v[96:99], v[92:95], 0
    ds_read_b128 v[196:199], v16 offset:3072
    v_mfma_f32_16x16x32_bf16 v[156:159], v[100:103], v[92:95], 0
    ds_read_b128 v[200:203], v17 offset:1024
    v_mfma_f32_16x16x32_bf16 v[152:155], v[100:103], v[88:91], 0
    ds_read_b128 v[204:207], v17 offset:3072
    v_mfma_f32_16x16x32_bf16 v[148:151], v[100:103], v[84:87], 0
    ds_read_b64_tr_b16 v[212:213], v19 offset:8192
    v_mfma_f32_16x16x32_bf16 v[144:147], v[100:103], v[80:83], 0
    ds_read_b64_tr_b16 v[214:215], v19 offset:12288
    v_mfma_f32_16x16x32_bf16 v[160:163], v[104:107], v[80:83], 0
    ds_read_b64_tr_b16 v[216:217], v20 offset:8192
    v_mfma_f32_16x16x32_bf16 v[164:167], v[104:107], v[84:87], 0
    ds_read_b64_tr_b16 v[218:219], v20 offset:12288
    v_mfma_f32_16x16x32_bf16 v[168:171], v[104:107], v[88:91], 0
    ds_read_b64_tr_b16 v[220:221], v21 offset:8192
    v_mfma_f32_16x16x32_bf16 v[172:175], v[104:107], v[92:95], 0
    ds_read_b64_tr_b16 v[222:223], v21 offset:12288
    v_mfma_f32_16x16x32_bf16 v[188:191], v[108:111], v[92:95], 0
    s_cmp_eq_u32 s42, 0
    v_mfma_f32_16x16x32_bf16 v[184:187], v[108:111], v[88:91], 0
    v_mfma_f32_16x16x32_bf16 v[180:183], v[108:111], v[84:87], 0
    v_mfma_f32_16x16x32_bf16 v[176:179], v[108:111], v[80:83], 0
    s_branch C2_mid0
C2_loop:
    s_waitcnt lgkmcnt(6)
    v_mfma_f32_16x16x32_bf16 v[128:131], v[96:99], v[80:83], v[128:131]
    ds_read_b64_tr_b16 v[208:209], v26 offset:24576
    v_mfma_f32_16x16x32_bf16 v[132:135], v[96:99], v[84:87], v[132:135]
    ds_read_b64_tr_b16 v[210:211], v26 offset:28672
    v_mfma_f32_16x16x32_bf16 v[136:139], v[96:99], v[88:91], v[136:139]
    ds_read_b128 v[192:195], v24 offset:1024
    v_mfma_f32_16x16x32_bf16 v[140:143], v[96:99], v[92:95], v[140:143]
    s_waitcnt lgkmcnt(7)
    v_mfma_f32_16x16x32_bf16 v[156:159], v[100:103], v[92:95], v[156:159]
    ds_read_b128 v[196:199], v24 offset:3072
    v_mfma_f32_16x16x32_bf16 v[152:155], v[100:103], v[88:91], v[152:155]
    ds_read_b128 v[200:203], v25 offset:1024
    v_mfma_f32_16x16x32_bf16 v[148:151], v[100:103], v[84:87], v[148:151]
    ds_read_b128 v[204:207], v25 offset:3072
    v_mfma_f32_16x16x32_bf16 v[144:147], v[100:103], v[80:83], v[144:147]
    s_waitcnt lgkmcnt(6)
    v_mfma_f32_16x16x32_bf16 v[160:163], v[104:107], v[80:83], v[160:163]
    ds_read_b64_tr_b16 v[212:213], v27 offset:24576
    v_mfma_f32_16x16x32_bf16 v[164:167], v[104:107], v[84:87], v[164:167]
    ds_read_b64_tr_b16 v[214:215], v27 offset:28672
    v_mfma_f32_16x16x32_bf16 v[168:171], v[104:107], v[88:91], v[168:171]
    ds_read_b64_tr_b16 v[216:217], v28 offset:24576
    v_mfma_f32_16x16x32_bf16 v[172:175], v[104:107], v[92:95], v[172:175]
    ds_read_b64_tr_b16 v[218:219], v28 offset:28672
    v_mfma_f32_16x16x32_bf16 v[188:191], v[108:111], v[92:95], v[188:191]
    ds_read_b64_tr_b16 v[220:221], v29 offset:24576
    v_mfma_f32_16x16x32_bf16 v[184:187], v[108:111], v[88:91], v[184:187]
    ds_read_b64_tr_b16 v[222:223], v29 offset:28672
    v_mfma_f32_16x16x32_bf16 v[180:183], v[108:111], v[84:87], v[180:183]
    s_cmp_eq_u32 s42, 0
    v_mfma_f32_16x16x32_bf16 v[176:179], v[108:111], v[80:83], v[176:179]
C2_mid0:
    s_waitcnt lgkmcnt(6)
    v_mfma_f32_16x16x32_bf16 v[128:131], v[208:211], v[192:195], v[128:131]
    v_mfma_f32_16x16x32_bf16 v[132:135], v[208:211], v[196:199], v[132:135]
    v_mfma_f32_16x16x32_bf16 v[136:139], v[208:211], v[200:203], v[136:139]
    v_mfma_f32_16x16x32_bf16 v[140:143], v[208:211], v[204:207], v[140:143]
    s_waitcnt lgkmcnt(0)
    s_cbranch_scc1 C2_b0
C2_bar0:
    s_barrier
C2_b0:
    ds_read_b64_tr_b16 v[96:97], v26 offset:32768
    v_mfma_f32_16x16x32_bf16 v[156:159], v[212:215], v[204:207], v[156:159]
    ds_read_b64_tr_b16 v[98:99], v26 offset:36864
    v_mfma_f32_16x16x32_bf16 v[152:155], v[212:215], v[200:203], v[152:155]
    ds_read_b128 v[80:83], v24 offset:16384
    v_mfma_f32_16x16x32_bf16 v[148:151], v[212:215], v[196:199], v[148:151]
    ds_read_b128 v[84:87], v24 offset:18432
    v_mfma_f32_16x16x32_bf16 v[144:147], v[212:215], v[192:195], v[144:147]
    ds_read_b128 v[88:91], v25 offset:16384
    v_mfma_f32_16x16x32_bf16 v[160:163], v[216:219], v[192:195], v[160:163]
    ds_read_b128 v[92:95], v25 offset:18432
    v_mfma_f32_16x16x32_bf16 v[164:167], v[216:219], v[196:199], v[164:167]
    ds_read_b64_tr_b16 v[100:101], v27 offset:32768
    v_mfma_f32_16x16x32_bf16 v[168:171], v[216:219], v[200:203], v[168:171]
    ds_read_b64_tr_b16 v[102:103], v27 offset:36864
    v_mfma_f32_16x16x32_bf16 v[172:175], v[216:219], v[204:207], v[172:175]
    ds_read_b64_tr_b16 v[104:105], v28 offset:32768
    v_mfma_f32_16x16x32_bf16 v[188:191], v[220:223], v[204:207], v[188:191]
    ds_read_b64_tr_b16 v[106:107], v28 offset:36864
    v_mfma_f32_16x16x32_bf16 v[184:187], v[220:223], v[200:203], v[184:187]
    ds_read_b64_tr_b16 v[108:109], v29 offset:32768
    v_mfma_f32_16x16x32_bf16 v[180:183], v[220:223], v[196:199], v[180:183]
    ds_read_b64_tr_b16 v[110:111], v29 offset:36864
    v_mfma_f32_16x16x32_bf16 v[176:179], v[220:223], v[192:195], v[176:179]
    s_waitcnt lgkmcnt(6)
    v_mfma_f32_16x16x32_bf16 v[128:131], v[96:99], v[80:83], v[128:131]
    ds_read_b64_tr_b16 v[208:209], v26 offset:40960
    v_mfma_f32_16x16x32_bf16 v[132:135], v[96:99], v[84:87], v[132:135]
    ds_read_b64_tr_b16 v[210:211], v26 offset:45056
    v_mfma_f32_16x16x32_bf16 v[136:139], v[96:99], v[88:91], v[136:139]
    ds_read_b128 v[192:195], v24 offset:17408
    v_mfma_f32_16x16x32_bf16 v[140:143], v[96:99], v[92:95], v[140:143]
    s_waitcnt lgkmcnt(7)
    v_mfma_f32_16x16x32_bf16 v[156:159], v[100:103], v[92:95], v[156:159]
    ds_read_b128 v[196:199], v24 offset:19456
    v_mfma_f32_16x16x32_bf16 v[152:155], v[100:103], v[88:91], v[152:155]
    ds_read_b128 v[200:203], v25 offset:17408
    v_mfma_f32_16x16x32_bf16 v[148:151], v[100:103], v[84:87], v[148:151]
    ds_read_b128 v[204:207], v25 offset:19456
    v_mfma_f32_16x16x32_bf16 v[144:147], v[100:103], v[80:83], v[144:147]
    s_waitcnt lgkmcnt(6)
    v_mfma_f32_16x16x32_bf16 v[160:163], v[104:107], v[80:83], v[160:163]
    ds_read_b64_tr_b16 v[212:213], v27 offset:40960
    v_mfma_f32_16x16x32_bf16 v[164:167], v[104:107], v[84:87], v[164:167]
    ds_read_b64_tr_b16 v[214:215], v27 offset:45056
    v_mfma_f32_16x16x32_bf16 v[168:171], v[104:107], v[88:91], v[168:171]
    ds_read_b64_tr_b16 v[216:217], v28 offset:40960
    v_mfma_f32_16x16x32_bf16 v[172:175], v[104:107], v[92:95], v[172:175]
    ds_read_b64_tr_b16 v[218:219], v28 offset:45056
    v_mfma_f32_16x16x32_bf16 v[188:191], v[108:111], v[92:95], v[188:191]
    ds_read_b64_tr_b16 v[220:221], v29 offset:40960
    v_mfma_f32_16x16x32_bf16 v[184:187], v[108:111], v[88:91], v[184:187]
    ds_read_b64_tr_b16 v[222:223], v29 offset:45056
    v_mfma_f32_16x16x32_bf16 v[180:183], v[108:111], v[84:87], v[180:183]
    s_cmp_eq_u32 s42, 5
    v_mfma_f32_16x16x32_bf16 v[176:179], v[108:111], v[80:83], v[176:179]
    s_cbranch_scc1 C2_tail
    s_cmp_eq_u32 s42, 0
C2_mid1:
    s_waitcnt lgkmcnt(6)
    v_mfma_f32_16x16x32_bf16 v[128:131], v[208:211], v[192:195], v[128:131]
    v_mfma_f32_16x16x32_bf16 v[132:135], v[208:211], v[196:199], v[132:135]
    v_mfma_f32_16x16x32_bf16 v[136:139], v[208:211], v[200:203], v[136:139]
    v_mfma_f32_16x16x32_bf16 v[140:143], v[208:211], v[204:207], v[140:143]
    s_waitcnt lgkmcnt(0)
    s_cbranch_scc1 C2_b1
C2_bar1:
    s_barrier
C2_b1:
    ds_read_b64_tr_b16 v[96:97], v26 offset:49152
    v_mfma_f32_16x16x32_bf16 v[156:159], v[212:215], v[204:207], v[156:159]
    ds_read_b64_tr_b16 v[98:99], v26 offset:53248
    v_mfma_f32_16x16x32_bf16 v[152:155], v[212:215], v[200:203], v[152:155]
    ds_read_b128 v[80:83], v24 offset:32768
    v_mfma_f32_16x16x32_bf16 v[148:151], v[212:215], v[196:199], v[148:151]
    ds_read_b128 v[84:87], v24 offset:34816
    v_mfma_f32_16x16x32_bf16 v[144:147], v[212:215], v[192:195], v[144:147]
    ds_read_b128 v[88:91], v25 offset:32768
    v_mfma_f32_16x16x32_bf16 v[160:163], v[216:219], v[192:195], v[160:163]
    ds_read_b128 v[92:95], v25 offset:34816
    v_mfma_f32_16x16x32_bf16 v[164:167], v[216:219], v[196:199], v[164:167]
    ds_read_b64_tr_b16 v[100:101], v27 offset:49152
    v_mfma_f32_16x16x32_bf16 v[168:171], v[216:219], v[200:203], v[168:171]
    ds_read_b64_tr_b16 v[102:103], v27 offset:53248
    v_mfma_f32_16x16x32_bf16 v[172:175], v[216:219], v[204:207], v[172:175]
    ds_read_b64_tr_b16 v[104:105], v28 offset:49152
    v_mfma_f32_16x16x32_bf16 v[188:191], v[220:223], v[204:207], v[188:191]
    ds_read_b64_tr_b16 v[106:107], v28 offset:53248
    v_mfma_f32_16x16x32_bf16 v[184:187], v[220:223], v[200:203], v[184:187]
    ds_read_b64_tr_b16 v[108:109], v29 offset:49152
    v_mfma_f32_16x16x32_bf16 v[180:183], v[220:223], v[196:199], v[180:183]
    ds_read_b64_tr_b16 v[110:111], v29 offset:53248
    v_mfma_f32_16x16x32_bf16 v[176:179], v[220:223], v[192:195], v[176:179]
    s_waitcnt lgkmcnt(6)
    v_mfma_f32_16x16x32_bf16 v[128:131], v[96:99], v[80:83], v[128:131]
    ds_read_b64_tr_b16 v[208:209], v26 offset:57344
    v_mfma_f32_16x16x32_bf16 v[132:135], v[96:99], v[84:87], v[132:135]
    ds_read_b64_tr_b16 v[210:211], v26 offset:61440
    v_mfma_f32_16x16x32_bf16 v[136:139], v[96:99], v[88:91], v[136:139]
    ds_read_b128 v[192:195], v24 offset:33792
    v_mfma_f32_16x16x32_bf16 v[140:143], v[96:99], v[92:95], v[140:143]
    s_waitcnt lgkmcnt(7)
    v_mfma_f32_16x16x32_bf16 v[156:159], v[100:103], v[92:95], v[156:159]
    ds_read_b128 v[196:199], v24 offset:35840
    v_mfma_f32_16x16x32_bf16 v[152:155], v[100:103], v[88:91], v[152:155]
    ds_read_b128 v[200:203], v25 offset:33792
    v_mfma_f32_16x16x32_bf16 v[148:151], v[100:103], v[84:87], v[148:151]
    ds_read_b128 v[204:207], v25 offset:35840
    v_mfma_f32_16x16x32_bf16 v[144:147], v[100:103], v[80:83], v[144:147]
    s_waitcnt lgkmcnt(6)
    v_mfma_f32_16x16x32_bf16 v[160:163], v[104:107], v[80:83], v[160:163]
    ds_read_b64_tr_b16 v[212:213], v27 offset:57344
    v_mfma_f32_16x16x32_bf16 v[164:167], v[104:107], v[84:87], v[164:167]
    ds_read_b64_tr_b16 v[214:215], v27 offset:61440
    v_mfma_f32_16x16x32_bf16 v[168:171], v[104:107], v[88:91], v[168:171]
    ds_read_b64_tr_b16 v[216:217], v28 offset:57344
    v_mfma_f32_16x16x32_bf16 v[172:175], v[104:107], v[92:95], v[172:175]
    ds_read_b64_tr_b16 v[218:219], v28 offset:61440
    v_mfma_f32_16x16x32_bf16 v[188:191], v[108:111], v[92:95], v[188:191]
    ds_read_b64_tr_b16 v[220:221], v29 offset:57344
    v_mfma_f32_16x16x32_bf16 v[184:187], v[108:111], v[88:91], v[184:187]
    ds_read_b64_tr_b16 v[222:223], v29 offset:61440
    v_mfma_f32_16x16x32_bf16 v[180:183], v[108:111], v[84:87], v[180:183]
    s_cmp_eq_u32 s42, 0
    v_mfma_f32_16x16x32_bf16 v[176:179], v[108:111], v[80:83], v[176:179]
C2_mid2:
    s_waitcnt lgkmcnt(6)
    v_mfma_f32_16x16x32_bf16 v[128:131], v[208:211], v[192:195], v[128:131]
    v_mfma_f32_16x16x32_bf16 v[132:135], v[208:211], v[196:199], v[132:135]
    v_mfma_f32_16x16x32_bf16 v[136:139], v[208:211], v[200:203], v[136:139]
    v_mfma_f32_16x16x32_bf16 v[140:143], v[208:211], v[204:207], v[140:143]
    s_waitcnt lgkmcnt(0)
    s_cbranch_scc1 C2_special
C2_bar2:
    s_barrier
C2_b2:
    ds_read_b64_tr_b16 v[96:97], v26 offset:0
    v_mfma_f32_16x16x32_bf16 v[156:159], v[212:215], v[204:207], v[156:159]
    ds_read_b64_tr_b16 v[98:99], v26 offset:4096
    v_mfma_f32_16x16x32_bf16 v[152:155], v[212:215], v[200:203], v[152:155]
    ds_read_b128 v[80:83], v24 offset:49152
    v_mfma_f32_16x16x32_bf16 v[148:151], v[212:215], v[196:199], v[148:151]
    ds_read_b128 v[84:87], v24 offset:51200
    v_mfma_f32_16x16x32_bf16 v[144:147], v[212:215], v[192:195], v[144:147]
    ds_read_b128 v[88:91], v25 offset:49152
    v_mfma_f32_16x16x32_bf16 v[160:163], v[216:219], v[192:195], v[160:163]
    ds_read_b128 v[92:95], v25 offset:51200
    v_mfma_f32_16x16x32_bf16 v[164:167], v[216:219], v[196:199], v[164:167]
    ds_read_b64_tr_b16 v[100:101], v27 offset:0
    v_mfma_f32_16x16x32_bf16 v[168:171], v[216:219], v[200:203], v[168:171]
    ds_read_b64_tr_b16 v[102:103], v27 offset:4096
    v_mfma_f32_16x16x32_bf16 v[172:175], v[216:219], v[204:207], v[172:175]
    ds_read_b64_tr_b16 v[104:105], v28 offset:0
    v_mfma_f32_16x16x32_bf16 v[188:191], v[220:223], v[204:207], v[188:191]
    ds_read_b64_tr_b16 v[106:107], v28 offset:4096
    v_mfma_f32_16x16x32_bf16 v[184:187], v[220:223], v[200:203], v[184:187]
    ds_read_b64_tr_b16 v[108:109], v29 offset:0
    v_mfma_f32_16x16x32_bf16 v[180:183], v[220:223], v[196:199], v[180:183]
    ds_read_b64_tr_b16 v[110:111], v29 offset:4096
    v_mfma_f32_16x16x32_bf16 v[176:179], v[220:223], v[192:195], v[176:179]
    s_waitcnt lgkmcnt(6)
    v_mfma_f32_16x16x32_bf16 v[128:131], v[96:99], v[80:83], v[128:131]
    ds_read_b64_tr_b16 v[208:209], v26 offset:8192
    v_mfma_f32_16x16x32_bf16 v[132:135], v[96:99], v[84:87], v[132:135]
    ds_read_b64_tr_b16 v[210:211], v26 offset:12288
    v_mfma_f32_16x16x32_bf16 v[136:139], v[96:99], v[88:91], v[136:139]
    ds_read_b128 v[192:195], v24 offset:50176
    v_mfma_f32_16x16x32_bf16 v[140:143], v[96:99], v[92:95], v[140:143]
    s_waitcnt lgkmcnt(7)
    v_mfma_f32_16x16x32_bf16 v[156:159], v[100:103], v[92:95], v[156:159]
    ds_read_b128 v[196:199], v24 offset:52224
    v_mfma_f32_16x16x32_bf16 v[152:155], v[100:103], v[88:91], v[152:155]
    ds_read_b128 v[200:203], v25 offset:50176
    v_mfma_f32_16x16x32_bf16 v[148:151], v[100:103], v[84:87], v[148:151]
    ds_read_b128 v[204:207], v25 offset:52224
    v_mfma_f32_16x16x32_bf16 v[144:147], v[100:103], v[80:83], v[144:147]
    s_waitcnt lgkmcnt(6)
    v_mfma_f32_16x16x32_bf16 v[160:163], v[104:107], v[80:83], v[160:163]
    ds_read_b64_tr_b16 v[212:213], v27 offset:8192
    v_mfma_f32_16x16x32_bf16 v[164:167], v[104:107], v[84:87], v[164:167]
    ds_read_b64_tr_b16 v[214:215], v27 offset:12288
    v_mfma_f32_16x16x32_bf16 v[168:171], v[104:107], v[88:91], v[168:171]
    ds_read_b64_tr_b16 v[216:217], v28 offset:8192
    v_mfma_f32_16x16x32_bf16 v[172:175], v[104:107], v[92:95], v[172:175]
    ds_read_b64_tr_b16 v[218:219], v28 offset:12288
    v_mfma_f32_16x16x32_bf16 v[188:191], v[108:111], v[92:95], v[188:191]
    ds_read_b64_tr_b16 v[220:221], v29 offset:8192
    v_mfma_f32_16x16x32_bf16 v[184:187], v[108:111], v[88:91], v[184:187]
    ds_read_b64_tr_b16 v[222:223], v29 offset:12288
    v_mfma_f32_16x16x32_bf16 v[180:183], v[108:111], v[84:87], v[180:183]
    s_cmp_eq_u32 s42, 0
    v_mfma_f32_16x16x32_bf16 v[176:179], v[108:111], v[80:83], v[176:179]
C2_mid3:
    s_waitcnt lgkmcnt(6)
    v_mfma_f32_16x16x32_bf16 v[128:131], v[208:211], v[192:195], v[128:131]
    v_mfma_f32_16x16x32_bf16 v[132:135], v[208:211], v[196:199], v[132:135]
    v_mfma_f32_16x16x32_bf16 v[136:139], v[208:211], v[200:203], v[136:139]
    v_mfma_f32_16x16x32_bf16 v[140:143], v[208:211], v[204:207], v[140:143]
    s_waitcnt lgkmcnt(0)
    s_cbranch_scc1 C2_b3
C2_bar3:
    s_barrier
C2_b3:
    ds_read_b64_tr_b16 v[96:97], v26 offset:16384
    v_mfma_f32_16x16x32_bf16 v[156:159], v[212:215], v[204:207], v[156:159]
    ds_read_b64_tr_b16 v[98:99], v26 offset:20480
    v_mfma_f32_16x16x32_bf16 v[152:155], v[212:215], v[200:203], v[152:155]
    ds_read_b128 v[80:83], v24 offset:0
    v_mfma_f32_16x16x32_bf16 v[148:151], v[212:215], v[196:199], v[148:151]
    ds_read_b128 v[84:87], v24 offset:2048
    v_mfma_f32_16x16x32_bf16 v[144:147], v[212:215], v[192:195], v[144:147]
    ds_read_b128 v[88:91], v25 offset:0
    v_mfma_f32_16x16x32_bf16 v[160:163], v[216:219], v[192:195], v[160:163]
    ds_read_b128 v[92:95], v25 offset:2048
    v_mfma_f32_16x16x32_bf16 v[164:167], v[216:219], v[196:199], v[164:167]
    ds_read_b64_tr_b16 v[100:101], v27 offset:16384
    v_mfma_f32_16x16x32_bf16 v[168:171], v[216:219], v[200:203], v[168:171]
    ds_read_b64_tr_b16 v[102:103], v27 offset:20480
    v_mfma_f32_16x16x32_bf16 v[172:175], v[216:219], v[204:207], v[172:175]
    ds_read_b64_tr_b16 v[104:105], v28 offset:16384
    v_mfma_f32_16x16x32_bf16 v[188:191], v[220:223], v[204:207], v[188:191]
    ds_read_b64_tr_b16 v[106:107], v28 offset:20480
    v_mfma_f32_16x16x32_bf16 v[184:187], v[220:223], v[200:203], v[184:187]
    ds_read_b64_tr_b16 v[108:109], v29 offset:16384
    v_mfma_f32_16x16x32_bf16 v[180:183], v[220:223], v[196:199], v[180:183]
    ds_read_b64_tr_b16 v[110:111], v29 offset:20480
    v_mfma_f32_16x16x32_bf16 v[176:179], v[220:223], v[192:195], v[176:179]
    s_add_u32 s42, s42, 1
    s_branch C2_loop
C2_tail:
    s_waitcnt lgkmcnt(6)
    v_mfma_f32_16x16x32_bf16 v[128:131], v[208:211], v[192:195], v[128:131]
    v_mfma_f32_16x16x32_bf16 v[132:135], v[208:211], v[196:199], v[132:135]
    v_mfma_f32_16x16x32_bf16 v[136:139], v[208:211], v[200:203], v[136:139]
    v_mfma_f32_16x16x32_bf16 v[140:143], v[208:211], v[204:207], v[140:143]
    s_waitcnt lgkmcnt(2)
    v_mfma_f32_16x16x32_bf16 v[156:159], v[212:215], v[204:207], v[156:159]
    v_mfma_f32_16x16x32_bf16 v[152:155], v[212:215], v[200:203], v[152:155]
    s_waitcnt lgkmcnt(0)
    s_barrier
    ds_read_b64_tr_b16 v[32:33], v26 offset:49152
    v_mfma_f32_16x16x32_bf16 v[148:151], v[212:215], v[196:199], v[148:151]
    ds_read_b64_tr_b16 v[34:35], v26 offset:53248
    ds_read_b128 v[36:39], v25 offset:32768
    v_mfma_f32_16x16x32_bf16 v[144:147], v[212:215], v[192:195], v[144:147]
    ds_read_b128 v[40:43], v25 offset:34816
    ds_read_b64_tr_b16 v[44:45], v27 offset:49152
    v_mfma_f32_16x16x32_bf16 v[160:163], v[216:219], v[192:195], v[160:163]
    ds_read_b64_tr_b16 v[46:47], v27 offset:53248
    ds_read_b64_tr_b16 v[48:49], v28 offset:49152
    v_mfma_f32_16x16x32_bf16 v[164:167], v[216:219], v[196:199], v[164:167]
    ds_read_b64_tr_b16 v[50:51], v28 offset:53248
    ds_read_b64_tr_b16 v[52:53], v29 offset:49152
    v_mfma_f32_16x16x32_bf16 v[168:171], v[216:219], v[200:203], v[168:171]
    ds_read_b64_tr_b16 v[54:55], v29 offset:53248
    ds_read_b64_tr_b16 v[56:57], v26 offset:57344
    v_mfma_f32_16x16x32_bf16 v[172:175], v[216:219], v[204:207], v[172:175]
    ds_read_b64_tr_b16 v[58:59], v26 offset:61440
    ds_read_b128 v[60:63], v25 offset:33792
    v_mfma_f32_16x16x32_bf16 v[188:191], v[220:223], v[204:207], v[188:191]
    ds_read_b128 v[64:67], v25 offset:35840
    ds_read_b64_tr_b16 v[68:69], v27 offset:57344
    v_mfma_f32_16x16x32_bf16 v[184:187], v[220:223], v[200:203], v[184:187]
    ds_read_b64_tr_b16 v[70:71], v27 offset:61440
    ds_read_b64_tr_b16 v[72:73], v28 offset:57344
    v_mfma_f32_16x16x32_bf16 v[180:183], v[220:223], v[196:199], v[180:183]
    ds_read_b64_tr_b16 v[74:75], v28 offset:61440
    ds_read_b64_tr_b16 v[76:77], v29 offset:57344
    v_mfma_f32_16x16x32_bf16 v[176:179], v[220:223], v[192:195], v[176:179]
    ds_read_b64_tr_b16 v[78:79], v29 offset:61440
    s_waitcnt lgkmcnt(14)
    v_mfma_f32_16x16x32_bf16 v[136:139], v[32:35], v[36:39], v[136:139]
    v_mfma_f32_16x16x32_bf16 v[140:143], v[32:35], v[40:43], v[140:143]
    v_mfma_f32_16x16x32_bf16 v[156:159], v[44:47], v[40:43], v[156:159]
    v_mfma_f32_16x16x32_bf16 v[152:155], v[44:47], v[36:39], v[152:155]
    s_waitcnt lgkmcnt(9)
    v_mfma_f32_16x16x32_bf16 v[168:171], v[48:51], v[36:39], v[168:171]
    v_mfma_f32_16x16x32_bf16 v[172:175], v[48:51], v[40:43], v[172:175]
    s_waitcnt lgkmcnt(0)
    s_barrier
    ds_read_b64_tr_b16 v[80:81], v26 offset:0
    v_mfma_f32_16x16x32_bf16 v[188:191], v[52:55], v[40:43], v[188:191]
    ds_read_b64_tr_b16 v[82:83], v26 offset:4096
    ds_read_b128 v[84:87], v25 offset:49152
    v_mfma_f32_16x16x32_bf16 v[184:187], v[52:55], v[36:39], v[184:187]
    ds_read_b128 v[88:91], v25 offset:51200
    ds_read_b64_tr_b16 v[92:93], v27 offset:0
    v_mfma_f32_16x16x32_bf16 v[136:139], v[56:59], v[60:63], v[136:139]
    ds_read_b64_tr_b16 v[94:95], v27 offset:4096
    ds_read_b64_tr_b16 v[96:97], v28 offset:0
    v_mfma_f32_16x16x32_bf16 v[140:143], v[56:59], v[64:67], v[140:143]
    ds_read_b64_tr_b16 v[98:99], v28 offset:4096
    ds_read_b64_tr_b16 v[100:101], v29 offset:0
    v_mfma_f32_16x16x32_bf16 v[156:159], v[68:71], v[64:67], v[156:159]
    ds_read_b64_tr_b16 v[102:103], v29 offset:4096
    ds_read_b64_tr_b16 v[104:105], v26 offset:8192
    v_mfma_f32_16x16x32_bf16 v[152:155], v[68:71], v[60:63], v[152:155]
    ds_read_b64_tr_b16 v[106:107], v26 offset:12288
    ds_read_b128 v[108:111], v25 offset:50176
    v_mfma_f32_16x16x32_bf16 v[168:171], v[72:75], v[60:63], v[168:171]
    ds_read_b128 v[112:115], v25 offset:52224
    ds_read_b64_tr_b16 v[116:117], v27 offset:8192
    v_mfma_f32_16x16x32_bf16 v[172:175], v[72:75], v[64:67], v[172:175]
    ds_read_b64_tr_b16 v[118:119], v27 offset:12288
    ds_read_b64_tr_b16 v[120:121], v28 offset:8192
    v_mfma_f32_16x16x32_bf16 v[188:191], v[76:79], v[64:67], v[188:191]
    ds_read_b64_tr_b16 v[122:123], v28 offset:12288
    ds_read_b64_tr_b16 v[124:125], v29 offset:8192
    v_mfma_f32_16x16x32_bf16 v[184:187], v[76:79], v[60:63], v[184:187]
    ds_read_b64_tr_b16 v[126:127], v29 offset:12288
    s_waitcnt lgkmcnt(14)
    v_mfma_f32_16x16x32_bf16 v[136:139], v[80:83], v[84:87], v[136:139]
    v_mfma_f32_16x16x32_bf16 v[140:143], v[80:83], v[88:91], v[140:143]
    v_mfma_f32_16x16x32_bf16 v[156:159], v[92:95], v[88:91], v[156:159]
    v_mfma_f32_16x16x32_bf16 v[152:155], v[92:95], v[84:87], v[152:155]
    s_waitcnt lgkmcnt(9)
    v_mfma_f32_16x16x32_bf16 v[168:171], v[96:99], v[84:87], v[168:171]
    v_mfma_f32_16x16x32_bf16 v[172:175], v[96:99], v[88:91], v[172:175]
    s_waitcnt lgkmcnt(0)
    s_barrier
    ds_read_b64_tr_b16 v[224:225], v26 offset:16384
    v_mfma_f32_16x16x32_bf16 v[188:191], v[100:103], v[88:91], v[188:191]
    ds_read_b64_tr_b16 v[226:227], v26 offset:20480
    ds_read_b128 v[228:231], v25 offset:0
    v_mfma_f32_16x16x32_bf16 v[184:187], v[100:103], v[84:87], v[184:187]
    ds_read_b128 v[232:235], v25 offset:2048
    ds_read_b64_tr_b16 v[236:237], v27 offset:16384
    v_mfma_f32_16x16x32_bf16 v[136:139], v[104:107], v[108:111], v[136:139]
    ds_read_b64_tr_b16 v[238:239], v27 offset:20480
    ds_read_b64_tr_b16 v[208:209], v28 offset:16384
    v_mfma_f32_16x16x32_bf16 v[140:143], v[104:107], v[112:115], v[140:143]
    ds_read_b64_tr_b16 v[210:211], v28 offset:20480
    ds_read_b64_tr_b16 v[212:213], v29 offset:16384
    v_mfma_f32_16x16x32_bf16 v[156:159], v[116:119], v[112:115], v[156:159]
    ds_read_b64_tr_b16 v[214:215], v29 offset:20480
    ds_read_b64_tr_b16 v[216:217], v26 offset:24576
    v_mfma_f32_16x16x32_bf16 v[152:155], v[116:119], v[108:111], v[152:155]
    ds_read_b64_tr_b16 v[218:219], v26 offset:28672
    ds_read_b128 v[204:207], v25 offset:1024
    v_mfma_f32_16x16x32_bf16 v[168:171], v[120:123], v[108:111], v[168:171]
    ds_read_b128 v[200:203], v25 offset:3072
    ds_read_b64_tr_b16 v[196:197], v27 offset:24576
    v_mfma_f32_16x16x32_bf16 v[172:175], v[120:123], v[112:115], v[172:175]
    ds_read_b64_tr_b16 v[198:199], v27 offset:28672
    ds_read_b64_tr_b16 v[192:193], v28 offset:24576
    v_mfma_f32_16x16x32_bf16 v[188:191], v[124:127], v[112:115], v[188:191]
    ds_read_b64_tr_b16 v[194:195], v28 offset:28672
    ds_read_b64_tr_b16 v[220:221], v29 offset:24576
    v_mfma_f32_16x16x32_bf16 v[184:187], v[124:127], v[108:111], v[184:187]
    ds_read_b64_tr_b16 v[222:223], v29 offset:28672
    s_waitcnt lgkmcnt(14)
    v_mfma_f32_16x16x32_bf16 v[136:139], v[224:227], v[228:231], v[136:139]
    v_mfma_f32_16x16x32_bf16 v[140:143], v[224:227], v[232:235], v[140:143]
    v_mfma_f32_16x16x32_bf16 v[156:159], v[236:239], v[232:235], v[156:159]
    v_mfma_f32_16x16x32_bf16 v[152:155], v[236:239], v[228:231], v[152:155]
    s_waitcnt lgkmcnt(9)
    v_mfma_f32_16x16x32_bf16 v[168:171], v[208:211], v[228:231], v[168:171]
    v_mfma_f32_16x16x32_bf16 v[172:175], v[208:211], v[232:235], v[172:175]
    s_barrier
    ds_read_b64_tr_b16 v[40:41], v26 offset:32768
    v_mfma_f32_16x16x32_bf16 v[188:191], v[212:215], v[232:235], v[188:191]
    ds_read_b64_tr_b16 v[42:43], v26 offset:36864
    ds_read_b128 v[36:39], v25 offset:16384
    v_mfma_f32_16x16x32_bf16 v[184:187], v[212:215], v[228:231], v[184:187]
    ds_read_b128 v[64:67], v25 offset:18432
    ds_read_b64_tr_b16 v[60:61], v27 offset:32768
    s_waitcnt lgkmcnt(6)
    v_mfma_f32_16x16x32_bf16 v[136:139], v[216:219], v[204:207], v[136:139]
    ds_read_b64_tr_b16 v[62:63], v27 offset:36864
    v_mfma_f32_16x16x32_bf16 v[140:143], v[216:219], v[200:203], v[140:143]
    ds_read_b64_tr_b16 v[88:89], v28 offset:32768
    ds_read_b64_tr_b16 v[90:91], v28 offset:36864
    v_mfma_f32_16x16x32_bf16 v[156:159], v[196:199], v[200:203], v[156:159]
    ds_read_b64_tr_b16 v[84:85], v29 offset:32768
    ds_read_b64_tr_b16 v[86:87], v29 offset:36864
    v_mfma_f32_16x16x32_bf16 v[152:155], v[196:199], v[204:207], v[152:155]
    ds_read_b64_tr_b16 v[112:113], v26 offset:40960
    ds_read_b64_tr_b16 v[114:115], v26 offset:45056
    v_mfma_f32_16x16x32_bf16 v[168:171], v[192:195], v[204:207], v[168:171]
    ds_read_b128 v[108:111], v25 offset:17408
    ds_read_b128 v[232:235], v25 offset:19456
    v_mfma_f32_16x16x32_bf16 v[172:175], v[192:195], v[200:203], v[172:175]
    ds_read_b64_tr_b16 v[228:229], v27 offset:40960
    ds_read_b64_tr_b16 v[230:231], v27 offset:45056
    s_waitcnt lgkmcnt(14)
    v_mfma_f32_16x16x32_bf16 v[188:191], v[220:223], v[200:203], v[188:191]
    ds_read_b64_tr_b16 v[200:201], v28 offset:40960
    v_mfma_f32_16x16x32_bf16 v[184:187], v[220:223], v[204:207], v[184:187]
    ds_read_b64_tr_b16 v[202:203], v28 offset:45056
    ds_read_b64_tr_b16 v[204:205], v29 offset:40960
    s_waitcnt lgkmcnt(14)
    v_mfma_f32_16x16x32_bf16 v[136:139], v[40:43], v[36:39], v[136:139]
    ds_read_b64_tr_b16 v[206:207], v29 offset:45056
    v_mfma_f32_16x16x32_bf16 v[140:143], v[40:43], v[64:67], v[140:143]
    s_waitcnt lgkmcnt(14)
    v_mfma_f32_16x16x32_bf16 v[156:159], v[60:63], v[64:67], v[156:159]
    v_mfma_f32_16x16x32_bf16 v[152:155], v[60:63], v[36:39], v[152:155]
    s_waitcnt lgkmcnt(10)
    v_mfma_f32_16x16x32_bf16 v[168:171], v[88:91], v[36:39], v[168:171]
    v_mfma_f32_16x16x32_bf16 v[172:175], v[88:91], v[64:67], v[172:175]
    s_barrier
    ds_read_b64_tr_b16 v[40:41], v26 offset:49152
    v_mfma_f32_16x16x32_bf16 v[188:191], v[84:87], v[64:67], v[188:191]
    ds_read_b64_tr_b16 v[42:43], v26 offset:53248
    ds_read_b128 v[60:63], v25 offset:32768
    v_mfma_f32_16x16x32_bf16 v[184:187], v[84:87], v[36:39], v[184:187]
    ds_read_b128 v[88:91], v25 offset:34816
    ds_read_b64_tr_b16 v[64:65], v27 offset:49152
    s_waitcnt lgkmcnt(8)
    v_mfma_f32_16x16x32_bf16 v[136:139], v[112:115], v[108:111], v[136:139]
    ds_read_b64_tr_b16 v[66:67], v27 offset:53248
    v_mfma_f32_16x16x32_bf16 v[140:143], v[112:115], v[232:235], v[140:143]
    ds_read_b64_tr_b16 v[36:37], v28 offset:49152
    ds_read_b64_tr_b16 v[38:39], v28 offset:53248
    v_mfma_f32_16x16x32_bf16 v[156:159], v[228:231], v[232:235], v[156:159]
    ds_read_b64_tr_b16 v[84:85], v29 offset:49152
    ds_read_b64_tr_b16 v[86:87], v29 offset:53248
    v_mfma_f32_16x16x32_bf16 v[152:155], v[228:231], v[108:111], v[152:155]
    ds_read_b64_tr_b16 v[112:113], v26 offset:57344
    ds_read_b64_tr_b16 v[114:115], v26 offset:61440
    s_waitcnt lgkmcnt(12)
    v_mfma_f32_16x16x32_bf16 v[168:171], v[200:203], v[108:111], v[168:171]
    ds_read_b128 v[228:231], v25 offset:33792
    v_mfma_f32_16x16x32_bf16 v[172:175], v[200:203], v[232:235], v[172:175]
    ds_read_b128 v[200:203], v25 offset:35840
    v_mfma_f32_16x16x32_bf16 v[188:191], v[204:207], v[232:235], v[188:191]
    ds_read_b64_tr_b16 v[232:233], v27 offset:57344
    ds_read_b64_tr_b16 v[234:235], v27 offset:61440
    v_mfma_f32_16x16x32_bf16 v[184:187], v[204:207], v[108:111], v[184:187]
    ds_read_b64_tr_b16 v[108:109], v28 offset:57344
    ds_read_b64_tr_b16 v[110:111], v28 offset:61440
    s_waitcnt lgkmcnt(14)
    v_mfma_f32_16x16x32_bf16 v[136:139], v[40:43], v[60:63], v[136:139]
    ds_read_b64_tr_b16 v[204:205], v29 offset:57344
    v_mfma_f32_16x16x32_bf16 v[140:143], v[40:43], v[88:91], v[140:143]
    ds_read_b64_tr_b16 v[206:207], v29 offset:61440
    s_waitcnt lgkmcnt(14)
    v_mfma_f32_16x16x32_bf16 v[156:159], v[64:67], v[88:91], v[156:159]
    v_mfma_f32_16x16x32_bf16 v[152:155], v[64:67], v[60:63], v[152:155]
    s_waitcnt lgkmcnt(10)
    v_mfma_f32_16x16x32_bf16 v[168:171], v[36:39], v[60:63], v[168:171]
    v_mfma_f32_16x16x32_bf16 v[172:175], v[36:39], v[88:91], v[172:175]
    s_barrier
    ds_read_b64_tr_b16 v[40:41], v26 offset:0
    v_mfma_f32_16x16x32_bf16 v[188:191], v[84:87], v[88:91], v[188:191]
    ds_read_b64_tr_b16 v[42:43], v26 offset:4096
    ds_read_b128 v[64:67], v25 offset:49152
    v_mfma_f32_16x16x32_bf16 v[184:187], v[84:87], v[60:63], v[184:187]
    ds_read_b128 v[36:39], v25 offset:51200
    ds_read_b64_tr_b16 v[88:89], v27 offset:0
    s_waitcnt lgkmcnt(9)
    v_mfma_f32_16x16x32_bf16 v[136:139], v[112:115], v[228:231], v[136:139]
    ds_read_b64_tr_b16 v[90:91], v27 offset:4096
    v_mfma_f32_16x16x32_bf16 v[140:143], v[112:115], v[200:203], v[140:143]
    ds_read_b64_tr_b16 v[60:61], v28 offset:0
    ds_read_b64_tr_b16 v[62:63], v28 offset:4096
    v_mfma_f32_16x16x32_bf16 v[156:159], v[232:235], v[200:203], v[156:159]
    ds_read_b64_tr_b16 v[84:85], v29 offset:0
    ds_read_b64_tr_b16 v[86:87], v29 offset:4096
    v_mfma_f32_16x16x32_bf16 v[152:155], v[232:235], v[228:231], v[152:155]
    ds_read_b64_tr_b16 v[112:113], v26 offset:8192
    ds_read_b64_tr_b16 v[114:115], v26 offset:12288
    s_waitcnt lgkmcnt(12)
    v_mfma_f32_16x16x32_bf16 v[168:171], v[108:111], v[228:231], v[168:171]
    ds_read_b128 v[232:235], v25 offset:50176
    v_mfma_f32_16x16x32_bf16 v[172:175], v[108:111], v[200:203], v[172:175]
    ds_read_b128 v[108:111], v25 offset:52224
    v_mfma_f32_16x16x32_bf16 v[188:191], v[204:207], v[200:203], v[188:191]
    ds_read_b64_tr_b16 v[200:201], v27 offset:8192
    ds_read_b64_tr_b16 v[202:203], v27 offset:12288
    v_mfma_f32_16x16x32_bf16 v[184:187], v[204:207], v[228:231], v[184:187]
    ds_read_b64_tr_b16 v[204:205], v28 offset:8192
    ds_read_b64_tr_b16 v[206:207], v28 offset:12288
    s_waitcnt lgkmcnt(14)
    v_mfma_f32_16x16x32_bf16 v[136:139], v[40:43], v[64:67], v[136:139]
    ds_read_b64_tr_b16 v[228:229], v29 offset:8192
    v_mfma_f32_16x16x32_bf16 v[140:143], v[40:43], v[36:39], v[140:143]
    ds_read_b64_tr_b16 v[230:231], v29 offset:12288
    s_waitcnt lgkmcnt(14)
    v_mfma_f32_16x16x32_bf16 v[156:159], v[88:91], v[36:39], v[156:159]
    v_mfma_f32_16x16x32_bf16 v[152:155], v[88:91], v[64:67], v[152:155]
    s_waitcnt lgkmcnt(10)
    v_mfma_f32_16x16x32_bf16 v[168:171], v[60:63], v[64:67], v[168:171]
    v_mfma_f32_16x16x32_bf16 v[172:175], v[60:63], v[36:39], v[172:175]
    v_mfma_f32_16x16x32_bf16 v[188:191], v[84:87], v[36:39], v[188:191]
    v_mfma_f32_16x16x32_bf16 v[184:187], v[84:87], v[64:67], v[184:187]
    s_waitcnt lgkmcnt(4)
    v_mfma_f32_16x16x32_bf16 v[136:139], v[112:115], v[232:235], v[136:139]
    v_and_b32 v2, 15, v0
    v_mfma_f32_16x16x32_bf16 v[140:143], v[112:115], v[108:111], v[140:143]
    v_and_b32 v4, 7, v0
    v_lshrrev_b32 v5, 1, v3
    v_mfma_f32_16x16x32_bf16 v[156:159], v[200:203], v[108:111], v[156:159]
    v_xor_b32 v5, v5, v4
    v_and_b32 v6, 1, v3
    v_mfma_f32_16x16x32_bf16 v[152:155], v[200:203], v[232:235], v[152:155]
    v_lshlrev_b32 v6, 3, v6
    v_lshl_add_u32 v6, v2, 7, v6
    s_waitcnt lgkmcnt(0)
    v_mfma_f32_16x16x32_bf16 v[168:171], v[204:207], v[232:235], v[168:171]
    v_add_u32 v6, s52, v6
    v_mfma_f32_16x16x32_bf16 v[172:175], v[204:207], v[108:111], v[172:175]
    v_xor_b32 v7, 0, v5
    v_lshl_add_u32 v8, v7, 4, v6
    buffer_store_dwordx4 v[136:139], v1, s[12:15], s84 offen offset:0 sc1
    buffer_store_dwordx4 v[140:143], v1, s[12:15], s84 offen offset:1024 sc1
    v_mfma_f32_16x16x32_bf16 v[188:191], v[228:231], v[108:111], v[188:191]
    v_mfma_f32_16x16x32_bf16 v[184:187], v[228:231], v[232:235], v[184:187]
    buffer_store_dwordx4 v[152:155], v1, s[12:15], s84 offen offset:2048 sc1
    buffer_store_dwordx4 v[156:159], v1, s[12:15], s84 offen offset:3072 sc1
    v_xor_b32 v7, 2, v5
    v_lshl_add_u32 v9, v7, 4, v6
    buffer_store_dwordx4 v[168:171], v1, s[12:15], s85 offen offset:0 sc1
    buffer_store_dwordx4 v[172:175], v1, s[12:15], s85 offen offset:1024 sc1
    v_xor_b32 v7, 4, v5
    v_lshl_add_u32 v10, v7, 4, v6
    v_xor_b32 v7, 6, v5
    buffer_store_dwordx4 v[184:187], v1, s[12:15], s85 offen offset:2048 sc1
    buffer_store_dwordx4 v[188:191], v1, s[12:15], s85 offen offset:3072 sc1
    s_barrier
    ds_read_b128 v[40:43], v252 offset:0
    ds_read_b128 v[88:91], v252 offset:2048
    ds_read_b128 v[60:63], v252 offset:1024
    ds_read_b128 v[36:39], v252 offset:3072
    ds_read_b128 v[64:67], v252 offset:8192
    ds_read_b128 v[84:87], v252 offset:10240
    ds_read_b128 v[112:115], v252 offset:9216
    ds_read_b128 v[200:203], v252 offset:11264
    ds_read_b128 v[204:207], v24 offset:0
    ds_read_b128 v[108:111], v24 offset:2048
    ds_read_b128 v[228:231], v24 offset:1024
    ds_read_b128 v[232:235], v24 offset:3072
    s_waitcnt lgkmcnt(11)
    v_mfma_f32_16x16x32_bf16 v[128:131], v[32:35], v[40:43], v[128:131]
    v_lshl_add_u32 v11, v7, 4, v6
    s_waitcnt lgkmcnt(10)
    v_mfma_f32_16x16x32_bf16 v[132:135], v[32:35], v[88:91], v[132:135]
    ds_read_b64_tr_b16 v[32:33], v26 offset:32768
    v_mfma_f32_16x16x32_bf16 v[148:151], v[44:47], v[88:91], v[148:151]
    ds_read_b64_tr_b16 v[34:35], v26 offset:36864
    v_lshrrev_b32 v5, 3, v0
    v_mfma_f32_16x16x32_bf16 v[144:147], v[44:47], v[40:43], v[144:147]
    ds_read_b128 v[44:47], v24 offset:16384
    v_xor_b32 v7, v5, v4
    v_mfma_f32_16x16x32_bf16 v[160:163], v[48:51], v[40:43], v[160:163]
    v_lshlrev_b32 v7, 4, v7
    v_lshl_add_u32 v7, v5, 7, v7
    v_mfma_f32_16x16x32_bf16 v[164:167], v[48:51], v[88:91], v[164:167]
    ds_read_b128 v[48:51], v24 offset:18432
    v_add_u32 v12, s52, v7
    v_mfma_f32_16x16x32_bf16 v[180:183], v[52:55], v[88:91], v[180:183]
    ds_read_b64_tr_b16 v[88:89], v27 offset:32768
    ds_read_b64_tr_b16 v[90:91], v27 offset:36864
    v_mfma_f32_16x16x32_bf16 v[176:179], v[52:55], v[40:43], v[176:179]
    ds_read_b64_tr_b16 v[40:41], v28 offset:32768
    ds_read_b64_tr_b16 v[42:43], v28 offset:36864
    s_waitcnt lgkmcnt(14)
    v_mfma_f32_16x16x32_bf16 v[128:131], v[56:59], v[60:63], v[128:131]
    ds_read_b64_tr_b16 v[52:53], v29 offset:32768
    v_mfma_f32_16x16x32_bf16 v[132:135], v[56:59], v[36:39], v[132:135]
    ds_read_b64_tr_b16 v[54:55], v29 offset:36864
    ds_read_b64_tr_b16 v[56:57], v26 offset:40960
    v_mfma_f32_16x16x32_bf16 v[148:151], v[68:71], v[36:39], v[148:151]
    ds_read_b64_tr_b16 v[58:59], v26 offset:45056
    v_lshlrev_b32 v13, 4, v4
    v_mfma_f32_16x16x32_bf16 v[144:147], v[68:71], v[60:63], v[144:147]
    ds_read_b128 v[68:71], v24 offset:17408
    v_lshl_add_u32 v13, v5, 11, v13
    v_mfma_f32_16x16x32_bf16 v[160:163], v[72:75], v[60:63], v[160:163]
    v_mfma_f32_16x16x32_bf16 v[164:167], v[72:75], v[36:39], v[164:167]
    ds_read_b128 v[72:75], v24 offset:19456
    v_mfma_f32_16x16x32_bf16 v[180:183], v[76:79], v[36:39], v[180:183]
    ds_read_b64_tr_b16 v[36:37], v27 offset:40960
    ds_read_b64_tr_b16 v[38:39], v27 offset:45056
    v_mfma_f32_16x16x32_bf16 v[176:179], v[76:79], v[60:63], v[176:179]
    ds_read_b64_tr_b16 v[60:61], v28 offset:40960
    ds_read_b64_tr_b16 v[62:63], v28 offset:45056
    v_mfma_f32_16x16x32_bf16 v[128:131], v[80:83], v[64:67], v[128:131]
    ds_read_b64_tr_b16 v[76:77], v29 offset:40960
    ds_read_b64_tr_b16 v[78:79], v29 offset:45056
    v_mfma_f32_16x16x32_bf16 v[132:135], v[80:83], v[84:87], v[132:135]
    v_mfma_f32_16x16x32_bf16 v[148:151], v[92:95], v[84:87], v[148:151]
    v_mfma_f32_16x16x32_bf16 v[144:147], v[92:95], v[64:67], v[144:147]
    v_mfma_f32_16x16x32_bf16 v[160:163], v[96:99], v[64:67], v[160:163]
    v_mfma_f32_16x16x32_bf16 v[164:167], v[96:99], v[84:87], v[164:167]
    v_mfma_f32_16x16x32_bf16 v[180:183], v[100:103], v[84:87], v[180:183]
    v_mfma_f32_16x16x32_bf16 v[176:179], v[100:103], v[64:67], v[176:179]
    s_waitcnt lgkmcnt(4)
    v_mfma_f32_16x16x32_bf16 v[128:131], v[104:107], v[112:115], v[128:131]
    v_mfma_f32_16x16x32_bf16 v[132:135], v[104:107], v[200:203], v[132:135]
    v_mfma_f32_16x16x32_bf16 v[148:151], v[116:119], v[200:203], v[148:151]
    v_mfma_f32_16x16x32_bf16 v[144:147], v[116:119], v[112:115], v[144:147]
    v_mfma_f32_16x16x32_bf16 v[160:163], v[120:123], v[112:115], v[160:163]
    v_mfma_f32_16x16x32_bf16 v[164:167], v[120:123], v[200:203], v[164:167]
    v_mfma_f32_16x16x32_bf16 v[180:183], v[124:127], v[200:203], v[180:183]
    v_mfma_f32_16x16x32_bf16 v[176:179], v[124:127], v[112:115], v[176:179]
    v_mfma_f32_16x16x32_bf16 v[128:131], v[224:227], v[204:207], v[128:131]
    v_mfma_f32_16x16x32_bf16 v[132:135], v[224:227], v[108:111], v[132:135]
    v_mfma_f32_16x16x32_bf16 v[148:151], v[236:239], v[108:111], v[148:151]
    v_mfma_f32_16x16x32_bf16 v[144:147], v[236:239], v[204:207], v[144:147]
    v_mfma_f32_16x16x32_bf16 v[160:163], v[208:211], v[204:207], v[160:163]
    v_mfma_f32_16x16x32_bf16 v[164:167], v[208:211], v[108:111], v[164:167]
    v_mfma_f32_16x16x32_bf16 v[180:183], v[212:215], v[108:111], v[180:183]
    v_mfma_f32_16x16x32_bf16 v[176:179], v[212:215], v[204:207], v[176:179]
    v_mfma_f32_16x16x32_bf16 v[128:131], v[216:219], v[228:231], v[128:131]
    v_mfma_f32_16x16x32_bf16 v[132:135], v[216:219], v[232:235], v[132:135]
    v_mfma_f32_16x16x32_bf16 v[148:151], v[196:199], v[232:235], v[148:151]
    v_mfma_f32_16x16x32_bf16 v[144:147], v[196:199], v[228:231], v[144:147]
    v_mfma_f32_16x16x32_bf16 v[160:163], v[192:195], v[228:231], v[160:163]
    s_waitcnt vmcnt(0)
    buffer_load_dwordx2 v[248:249], v246, s[12:15], s89 offen sc1
    s_mov_b64 exec, 1
    buffer_store_dwordx2 v[244:245], v246, s[12:15], s88 offen sc1
    s_mov_b64 exec, -1
    v_mfma_f32_16x16x32_bf16 v[164:167], v[192:195], v[232:235], v[164:167]
    v_mfma_f32_16x16x32_bf16 v[180:183], v[220:223], v[232:235], v[180:183]
    v_mfma_f32_16x16x32_bf16 v[176:179], v[220:223], v[228:231], v[176:179]
    v_mfma_f32_16x16x32_bf16 v[128:131], v[32:35], v[44:47], v[128:131]
    v_mfma_f32_16x16x32_bf16 v[132:135], v[32:35], v[48:51], v[132:135]
    v_mfma_f32_16x16x32_bf16 v[148:151], v[88:91], v[48:51], v[148:151]
    v_mfma_f32_16x16x32_bf16 v[144:147], v[88:91], v[44:47], v[144:147]
    v_mfma_f32_16x16x32_bf16 v[160:163], v[40:43], v[44:47], v[160:163]
    v_mfma_f32_16x16x32_bf16 v[164:167], v[40:43], v[48:51], v[164:167]
    v_mfma_f32_16x16x32_bf16 v[180:183], v[52:55], v[48:51], v[180:183]
    v_mfma_f32_16x16x32_bf16 v[176:179], v[52:55], v[44:47], v[176:179]
    v_mfma_f32_16x16x32_bf16 v[128:131], v[56:59], v[68:71], v[128:131]
    v_mfma_f32_16x16x32_bf16 v[132:135], v[56:59], v[72:75], v[132:135]
    v_mfma_f32_16x16x32_bf16 v[148:151], v[36:39], v[72:75], v[148:151]
    s_barrier
    ds_read_b64_tr_b16 v[80:81], v26 offset:49152
    v_mfma_f32_16x16x32_bf16 v[144:147], v[36:39], v[68:71], v[144:147]
    ds_read_b64_tr_b16 v[82:83], v26 offset:53248
    ds_read_b128 v[92:95], v24 offset:32768
    s_waitcnt lgkmcnt(3)
    v_mfma_f32_16x16x32_bf16 v[160:163], v[60:63], v[68:71], v[160:163]
    ds_read_b128 v[96:99], v24 offset:34816
    v_mfma_f32_16x16x32_bf16 v[164:167], v[60:63], v[72:75], v[164:167]
    ds_read_b64_tr_b16 v[84:85], v27 offset:49152
    ds_read_b64_tr_b16 v[86:87], v27 offset:53248
    v_mfma_f32_16x16x32_bf16 v[180:183], v[76:79], v[72:75], v[180:183]
    ds_read_b64_tr_b16 v[64:65], v28 offset:49152
    ds_read_b64_tr_b16 v[66:67], v28 offset:53248
    v_mfma_f32_16x16x32_bf16 v[176:179], v[76:79], v[68:71], v[176:179]
    ds_read_b64_tr_b16 v[100:101], v29 offset:49152
    ds_read_b64_tr_b16 v[102:103], v29 offset:53248
    s_waitcnt lgkmcnt(7)
    v_mfma_f32_16x16x32_bf16 v[128:131], v[80:83], v[92:95], v[128:131]
    ds_read_b64_tr_b16 v[104:105], v26 offset:57344
    s_waitcnt lgkmcnt(7)
    v_mfma_f32_16x16x32_bf16 v[132:135], v[80:83], v[96:99], v[132:135]
    ds_read_b64_tr_b16 v[106:107], v26 offset:61440
    s_waitcnt lgkmcnt(6)
    v_mfma_f32_16x16x32_bf16 v[148:151], v[84:87], v[96:99], v[148:151]
    ds_read_b128 v[116:119], v24 offset:33792
    v_mfma_f32_16x16x32_bf16 v[144:147], v[84:87], v[92:95], v[144:147]
    ds_read_b128 v[120:123], v24 offset:35840
    ds_read_b64_tr_b16 v[200:201], v27 offset:57344
    s_waitcnt lgkmcnt(7)
    v_mfma_f32_16x16x32_bf16 v[160:163], v[64:67], v[92:95], v[160:163]
    ds_read_b64_tr_b16 v[202:203], v27 offset:61440
    v_mfma_f32_16x16x32_bf16 v[164:167], v[64:67], v[96:99], v[164:167]
    ds_read_b64_tr_b16 v[112:113], v28 offset:57344
    ds_read_b64_tr_b16 v[114:115], v28 offset:61440
    s_waitcnt lgkmcnt(8)
    v_mfma_f32_16x16x32_bf16 v[180:183], v[100:103], v[96:99], v[180:183]
    ds_read_b64_tr_b16 v[124:125], v29 offset:57344
    v_mfma_f32_16x16x32_bf16 v[176:179], v[100:103], v[92:95], v[176:179]
    ds_read_b64_tr_b16 v[126:127], v29 offset:61440
    ds_read_b64_tr_b16 v[224:225], v26 offset:0
    s_waitcnt lgkmcnt(8)
    v_mfma_f32_16x16x32_bf16 v[128:131], v[104:107], v[116:119], v[128:131]
    s_waitcnt vmcnt(1)
    v_cmp_eq_u64 vcc, v[248:249], v[244:245]
    s_nop 1
    s_cmp_eq_u64 vcc, -1
    s_cbranch_scc0 C_e0
    buffer_load_dwordx4 v[136:139], v1, s[12:15], s86 offen offset:0 sc1
    buffer_load_dwordx4 v[140:143], v1, s[12:15], s86 offen offset:1024 sc1
    buffer_load_dwordx4 v[152:155], v1, s[12:15], s86 offen offset:2048 sc1
    buffer_load_dwordx4 v[156:159], v1, s[12:15], s86 offen offset:3072 sc1
    buffer_load_dwordx4 v[168:171], v1, s[12:15], s87 offen offset:0 sc1
    buffer_load_dwordx4 v[172:175], v1, s[12:15], s87 offen offset:1024 sc1
    buffer_load_dwordx4 v[184:187], v1, s[12:15], s87 offen offset:2048 sc1
    buffer_load_dwordx4 v[188:191], v1, s[12:15], s87 offen offset:3072 sc1
    s_branch C_e1
C_e0:
    buffer_load_dwordx2 v[248:249], v246, s[12:15], s89 offen sc1
C_e1:
    ds_read_b64_tr_b16 v[226:227], v26 offset:4096
    s_waitcnt lgkmcnt(8)
    v_mfma_f32_16x16x32_bf16 v[132:135], v[104:107], v[120:123], v[132:135]
    ds_read_b128 v[236:239], v24 offset:49152
    s_waitcnt lgkmcnt(7)
    v_mfma_f32_16x16x32_bf16 v[148:151], v[200:203], v[120:123], v[148:151]
    ds_read_b128 v[208:211], v24 offset:51200
    v_mfma_f32_16x16x32_bf16 v[144:147], v[200:203], v[116:119], v[144:147]
    ds_read_b64_tr_b16 v[108:109], v27 offset:0
    ds_read_b64_tr_b16 v[110:111], v27 offset:4096
    s_waitcnt lgkmcnt(8)
    v_mfma_f32_16x16x32_bf16 v[160:163], v[112:115], v[116:119], v[160:163]
    ds_read_b64_tr_b16 v[204:205], v28 offset:0
    v_mfma_f32_16x16x32_bf16 v[164:167], v[112:115], v[120:123], v[164:167]
    ds_read_b64_tr_b16 v[206:207], v28 offset:4096
    ds_read_b64_tr_b16 v[212:213], v29 offset:0
    s_waitcnt lgkmcnt(9)
    v_mfma_f32_16x16x32_bf16 v[180:183], v[124:127], v[120:123], v[180:183]
    ds_read_b64_tr_b16 v[214:215], v29 offset:4096
    v_mfma_f32_16x16x32_bf16 v[176:179], v[124:127], v[116:119], v[176:179]
    ds_read_b64_tr_b16 v[216:217], v26 offset:8192
    ds_read_b64_tr_b16 v[218:219], v26 offset:12288
    s_waitcnt lgkmcnt(9)
    v_mfma_f32_16x16x32_bf16 v[128:131], v[224:227], v[236:239], v[128:131]
    ds_read_b128 v[196:199], v24 offset:50176
    s_waitcnt lgkmcnt(9)
    v_mfma_f32_16x16x32_bf16 v[132:135], v[224:227], v[208:211], v[132:135]
    ds_read_b128 v[192:195], v24 offset:52224
    s_waitcnt lgkmcnt(8)
    v_mfma_f32_16x16x32_bf16 v[148:151], v[108:111], v[208:211], v[148:151]
    ds_read_b64_tr_b16 v[232:233], v27 offset:8192
    v_mfma_f32_16x16x32_bf16 v[144:147], v[108:111], v[236:239], v[144:147]
    ds_read_b64_tr_b16 v[234:235], v27 offset:12288
    ds_read_b64_tr_b16 v[220:221], v28 offset:8192
    s_waitcnt lgkmcnt(9)
    v_mfma_f32_16x16x32_bf16 v[160:163], v[204:207], v[236:239], v[160:163]
    ds_read_b64_tr_b16 v[222:223], v28 offset:12288
    v_mfma_f32_16x16x32_bf16 v[164:167], v[204:207], v[208:211], v[164:167]
    ds_read_b64_tr_b16 v[228:229], v29 offset:8192
    ds_read_b64_tr_b16 v[230:231], v29 offset:12288
    s_waitcnt lgkmcnt(10)
    v_mfma_f32_16x16x32_bf16 v[180:183], v[212:215], v[208:211], v[180:183]
    v_mfma_f32_16x16x32_bf16 v[176:179], v[212:215], v[236:239], v[176:179]
    s_waitcnt lgkmcnt(7)
    v_mfma_f32_16x16x32_bf16 v[128:131], v[216:219], v[196:199], v[128:131]
    s_waitcnt lgkmcnt(6)
    v_mfma_f32_16x16x32_bf16 v[132:135], v[216:219], v[192:195], v[132:135]
    s_waitcnt lgkmcnt(4)
    v_mfma_f32_16x16x32_bf16 v[148:151], v[232:235], v[192:195], v[148:151]
    v_mfma_f32_16x16x32_bf16 v[144:147], v[232:235], v[196:199], v[144:147]
    s_waitcnt lgkmcnt(2)
    v_mfma_f32_16x16x32_bf16 v[160:163], v[220:223], v[196:199], v[160:163]
    v_mfma_f32_16x16x32_bf16 v[164:167], v[220:223], v[192:195], v[164:167]
    s_waitcnt lgkmcnt(0)
    v_mfma_f32_16x16x32_bf16 v[180:183], v[228:231], v[192:195], v[180:183]
    v_mfma_f32_16x16x32_bf16 v[176:179], v[228:231], v[196:199], v[176:179]
    s_cbranch_scc1 C_have
    s_waitcnt vmcnt(0)
    v_cmp_eq_u64 vcc, v[248:249], v[244:245]
    s_nop 1
    s_cmp_eq_u64 vcc, -1
    s_cbranch_scc1 C_got
    buffer_load_dwordx2 v[248:249], v246, s[12:15], s89 offen sc1
C_poll:
    s_waitcnt vmcnt(0)
    v_cmp_eq_u64 vcc, v[248:249], v[244:245]
    s_nop 1
    s_cmp_eq_u64 vcc, -1
    s_cbranch_scc1 C_got
    s_sleep 1
    buffer_load_dwordx2 v[248:249], v246, s[12:15], s89 offen sc1
    s_branch C_poll
C_got:
    buffer_load_dwordx4 v[136:139], v1, s[12:15], s86 offen offset:0 sc1
    buffer_load_dwordx4 v[140:143], v1, s[12:15], s86 offen offset:1024 sc1
    buffer_load_dwordx4 v[152:155], v1, s[12:15], s86 offen offset:2048 sc1
    buffer_load_dwordx4 v[156:159], v1, s[12:15], s86 offen offset:3072 sc1
    buffer_load_dwordx4 v[168:171], v1, s[12:15], s87 offen offset:0 sc1
    buffer_load_dwordx4 v[172:175], v1, s[12:15], s87 offen offset:1024 sc1
    buffer_load_dwordx4 v[184:187], v1, s[12:15], s87 offen offset:2048 sc1
    buffer_load_dwordx4 v[188:191], v1, s[12:15], s87 offen offset:3072 sc1
C_have:
    s_nop 4
    s_waitcnt vmcnt(7)
    v_add_f32 v128, v128, v136
    v_add_f32 v129, v129, v137
    v_add_f32 v130, v130, v138
    v_add_f32 v131, v131, v139
    v_cvt_pk_bf16_f32 v80, v128, v129
    v_cvt_pk_bf16_f32 v81, v130, v131
    ds_write_b64 v8, v[80:81] offset:0
    s_waitcnt vmcnt(6)
    v_add_f32 v132, v132, v140
    v_add_f32 v133, v133, v141
    v_add_f32 v134, v134, v142
    v_add_f32 v135, v135, v143
    v_cvt_pk_bf16_f32 v82, v132, v133
    v_cvt_pk_bf16_f32 v83, v134, v135
    ds_write_b64 v8, v[82:83] offset:2048
    s_waitcnt vmcnt(5)
    v_add_f32 v144, v144, v152
    v_add_f32 v145, v145, v153
    v_add_f32 v146, v146, v154
    v_add_f32 v147, v147, v155
    v_cvt_pk_bf16_f32 v84, v144, v145
    v_cvt_pk_bf16_f32 v85, v146, v147
    ds_write_b64 v9, v[84:85] offset:0
    s_waitcnt vmcnt(4)
    v_add_f32 v148, v148, v156
    v_add_f32 v149, v149, v157
    v_add_f32 v150, v150, v158
    v_add_f32 v151, v151, v159
    v_cvt_pk_bf16_f32 v86, v148, v149
    v_cvt_pk_bf16_f32 v87, v150, v151
    ds_write_b64 v9, v[86:87] offset:2048
    s_waitcnt vmcnt(3)
    v_add_f32 v160, v160, v168
    v_add_f32 v161, v161, v169
    v_add_f32 v162, v162, v170
    v_add_f32 v163, v163, v171
    v_cvt_pk_bf16_f32 v88, v160, v161
    v_cvt_pk_bf16_f32 v89, v162, v163
    ds_write_b64 v10, v[88:89] offset:0
    s_waitcnt vmcnt(2)
    v_add_f32 v164, v164, v172
    v_add_f32 v165, v165, v173
    v_add_f32 v166, v166, v174
    v_add_f32 v167, v167, v175
    v_cvt_pk_bf16_f32 v90, v164, v165
    v_cvt_pk_bf16_f32 v91, v166, v167
    ds_write_b64 v10, v[90:91] offset:2048
    s_waitcnt vmcnt(1)
    v_add_f32 v176, v176, v184
    v_add_f32 v177, v177, v185
    v_add_f32 v178, v178, v186
    v_add_f32 v179, v179, v187
    v_cvt_pk_bf16_f32 v92, v176, v177
    v_cvt_pk_bf16_f32 v93, v178, v179
    ds_write_b64 v11, v[92:93] offset:0
    s_waitcnt vmcnt(0)
    v_add_f32 v180, v180, v188
    v_add_f32 v181, v181, v189
    v_add_f32 v182, v182, v190
    v_add_f32 v183, v183, v191
    v_cvt_pk_bf16_f32 v94, v180, v181
    v_cvt_pk_bf16_f32 v95, v182, v183
    ds_write_b64 v11, v[94:95] offset:2048
    s_waitcnt lgkmcnt(0)
    ds_read_b128 v[96:99], v12 offset:0
    ds_read_b128 v[100:103], v12 offset:1024
    ds_read_b128 v[104:107], v12 offset:2048
    ds_read_b128 v[108:111], v12 offset:3072
    s_waitcnt lgkmcnt(3)
    buffer_store_dwordx4 v[96:99], v13, s[96:99], s48 offen sc1
    s_waitcnt lgkmcnt(2)
    buffer_store_dwordx4 v[100:103], v13, s[96:99], s49 offen sc1
    s_waitcnt lgkmcnt(1)
    buffer_store_dwordx4 v[104:107], v13, s[96:99], s50 offen sc1
    s_waitcnt lgkmcnt(0)
    buffer_store_dwordx4 v[108:111], v13, s[96:99], s51 offen sc1
L_end:
    s_endpgm
C2_special:
    s_load_dwordx2 s[30:31], s[56:57], 0
    s_barrier
    s_waitcnt lgkmcnt(0)
    v_mov_b32 v244, s30
    v_mov_b32 v245, s31
    s_cmp_lg_u32 s31, 0
    s_cbranch_scc1 C2_b2
C_nonce:
    buffer_load_dwordx2 v[244:245], v246, s[44:47], 0 offen sc1
    s_waitcnt vmcnt(0)
    v_readfirstlane_b32 s29, v245
    s_cmp_lg_u32 s29, 0
    s_cbranch_scc1 C2_b2
    s_sleep 8
    s_branch C_nonce
L_code_end:
    s_endpgm
.section .rodata,"a"
.p2align 6
.amdhsa_kernel standalone__dense_activation_relu__prompt_kernel
  .amdhsa_next_free_vgpr 256
  .amdhsa_next_free_sgpr 102
  .amdhsa_accum_offset 256
  .amdhsa_group_segment_fixed_size 0
  .amdhsa_kernarg_size 48
  .amdhsa_user_sgpr_count 2
  .amdhsa_user_sgpr_kernarg_segment_ptr 1
  .amdhsa_system_sgpr_workgroup_id_x 1
.end_amdhsa_kernel
```
